```python
import torch

def _softmax(x, axis=-1):
    return torch.softmax(x, dim=axis)
def _gelu(x):
    return torch.nn.functional.gelu(x, approximate="tanh")
def _silu(x):
    return torch.nn.functional.silu(x)
def _sigmoid(x):
    return torch.sigmoid(x)
def _layernorm(x, axis=-1, eps=1e-5):
    m = x.mean(dim=axis, keepdim=True)
    v = x.var(dim=axis, keepdim=True, unbiased=False)
    return (x - m) / torch.sqrt(v + eps)
def _scatter_add(tgt, idx, src, axis=0):
    return tgt.clone().index_add_(axis, idx, src)
def _segment_sum(src, seg, n):
    out = torch.zeros((n,) + src.shape[1:], dtype=src.dtype)
    return out.index_add_(0, seg, src)
def _pad(x, pw):
    flat = tuple(v for pair in reversed(pw) for v in pair)
    return torch.nn.functional.pad(x, flat)

kernel_name = 'gated_mix__softmax_full_mha__mixer_token_mlp__prompt'

def setup_inputs():

    _w = (lambda a: (lambda t: t.to(torch.bfloat16) if t.is_floating_point() else t)(torch.as_tensor(a)))
    def _A_setup():
        B, S, D = 1, 2048, 512
        return {
            "x": _w((lambda *s: torch.randn(*s, dtype=torch.bfloat16) * 0.05)(B, S, D)),
            "wqkv": _w((lambda *s: torch.randn(*s, dtype=torch.bfloat16) * 0.8)(D, 3 * D)),
            "wo": _w((lambda *s: torch.randn(*s, dtype=torch.bfloat16) * 0.05)(D, D)),
        }
    _A_in = _A_setup()

    def _B_setup():
        B, S, D, F = 1, 2048, 512, 1792
        return {
            "x": _w((lambda *s: torch.randn(*s, dtype=torch.bfloat16) * 0.05)(B, S, D)),
            "w1": _w((lambda *s: torch.randn(*s, dtype=torch.bfloat16) * 0.8)(S, F) * (S ** -0.5)),
            "b1": _w((lambda *s: torch.randn(*s, dtype=torch.bfloat16) * 12.8)(F) * 0.02),
            "w2": _w((lambda *s: torch.randn(*s, dtype=torch.bfloat16) * 0.05)(F, S) * (F ** -0.5)),
            "b2": _w((lambda *s: torch.randn(*s, dtype=torch.bfloat16) * 0.8)(S) * 0.02),
        }
    _B_in = _B_setup()

    return {
        "A_x": _A_in["x"],
        "A_wqkv": _A_in["wqkv"],
        "A_wo": _A_in["wo"],
        "B_x": _B_in["x"],
        "B_w1": _B_in["w1"],
        "B_b1": _B_in["b1"],
        "B_w2": _B_in["w2"],
        "B_b2": _B_in["b2"],
        "gate_w": _w((lambda *s: torch.randn(*s, dtype=torch.bfloat16) * 0.05)(512) * 16.0),
    }

def reference(A_x, A_wqkv, A_wo, B_x, B_w1, B_b1, B_w2, B_b2, gate_w):
    def _A_ref(x, wqkv, wo):
        B, S, D = x.shape
        H = 32; Dh = D // H
        qkv = (lambda x, *d: x.permute(*d))((x @ wqkv).reshape(B, S, 3, H, Dh), 2, 0, 3, 1, 4)
        q, k, v = qkv[0], qkv[1], qkv[2]
        scale = Dh ** -0.5
        scores = torch.einsum("bhqd,bhkd->bhqk", q, k) * scale
        p = _softmax(scores, axis=-1)
        o = torch.einsum("bhqk,bhkd->bhqd", p, v)
        return (lambda x, *d: x.permute(*d))(o, 0, 2, 1, 3).reshape(B, S, D) @ wo

    def _B_ref(x, w1, b1, w2, b2):
        B, S, D = x.shape
        h = _layernorm(x, axis=-1)
        u = torch.einsum("bsd,sf->bdf", h, w1) + b1
        u = _gelu(u)
        y = torch.einsum("bdf,fs->bds", u, w2) + b2
        return (lambda x, *d: x.permute(*d))(y, 0, 2, 1)

    x = A_x
    g = _sigmoid((x * gate_w).sum(-1, keepdims=True))
    a = _A_ref(x, A_wqkv, A_wo)
    b = _B_ref(x, B_w1, B_b1, B_w2, B_b2)
    return g * a + (1 - g) * b
```

```asm
; @launch grid=(256,1,1) block=(768,1,1) lds=163840
.amdgcn_target "amdgcn-amd-amdhsa--gfx950"
.text
.globl gated_mix__softmax_full_mha__mixer_token_mlp__prompt_kernel
.p2align 8
.type gated_mix__softmax_full_mha__mixer_token_mlp__prompt_kernel,@function
gated_mix__softmax_full_mha__mixer_token_mlp__prompt_kernel:
    s_cmp_ge_u32 s2, 256
    s_cbranch_scc1 L_end
    s_load_dwordx16 s[16:31], s[0:1], 0
    s_load_dwordx8 s[32:39], s[0:1], 64
    v_lshrrev_b32 v1, 6, v0
    v_lshlrev_b32 v2, 6, v0
    v_readfirstlane_b32 s3, v1
    s_and_b32 s4, s2, 7
    s_lshr_b32 s5, s2, 3
    s_cmp_lg_u32 s3, 0
    s_cbranch_scc1 L_nocp
    s_getpc_b64 s[40:41]
    s_mov_b32 s42, L_end - gated_mix__softmax_full_mha__mixer_token_mlp__prompt_kernel - 64
    s_mov_b32 s43, 0x20000
    s_lshl_b32 s6, s5, 11
    s_mov_b32 exec_hi, 0
    buffer_load_dword v1, v2, s[40:43], s6 offen
    s_mov_b64 exec, -1
L_nocp:
    v_and_b32 v0, 63, v0
    s_mov_b32 s70, 0x800000
    s_cmp_ge_u32 s3, 4
    s_cbranch_scc0 L_cons
    s_cmp_lt_u32 s3, 8
    s_cbranch_scc1 L_prod
    s_waitcnt lgkmcnt(0)
    s_cmp_lg_u32 s3, 8
    s_cbranch_scc1 L_mix
    s_add_u32 s56, s38, 0xc80000
    s_addc_u32 s57, s39, 0
    s_mov_b32 s58, 0x20100
    s_mov_b32 s59, 0x20000
    v_mov_b32 v7, 0
    s_mov_b32 s6, 131072
    buffer_load_dword v60, v7, s[56:59], s6 offen
    s_branch L_mix
L_prod:
    s_sub_u32 s10, s3, 4
    v_lshrrev_b32 v10, 3, v0
    v_and_b32 v11, 7, v0
    v_lshrrev_b32 v12, 4, v0
    s_lshl_b32 s11, s10, 4
    v_add_u32 v10, s11, v10
    v_xor_b32 v13, v12, v11
    v_lshlrev_b32_e64 v13, 4, v13
    v_lshl_add_u32 v2, v10, 10, v13
    v_xor_b32_e64 v3, 64, v2
    v_add_u32 v3, 8192, v3
    s_movk_i32 s6, 3072
    v_mul_u32_u24 v10, s6, v10
    v_and_b32 v12, 1, v12
    v_lshlrev_b32 v12, 2, v12
    v_xor_b32_e64 v12, v12, v11
    v_lshl_add_u32 v4, v12, 4, v10
    v_add_u32 v5, 24576, v4
    s_lshl_b32 s11, s10, 11
    s_add_u32 s15, s4, s5
    s_and_b32 s15, s15, 7
    s_lshl_b32 s6, s5, 16
    s_lshl_b32 s7, s4, 7
    s_mov_b32 s42, 0x10000
    s_mov_b32 s43, 0x20000
    s_sub_u32 s46, 1572864, s7
    s_mov_b32 s47, 0x20000
    s_waitcnt lgkmcnt(0)
    s_add_u32 s40, s16, s6
    s_addc_u32 s41, s17, 0
    s_add_u32 s44, s18, s7
    s_addc_u32 s45, s19, 0
    s_lshl_b32 s12, s15, 7
    s_mul_i32 s13, s15, 196608
    s_mov_b32 s7, s13
    s_add_u32 m0, s11, 65536
    s_nop 0
    buffer_load_dwordx4 v4, s[44:47], s7 offen lds
    s_add_u32 m0, s11, 66560
    s_nop 0
    buffer_load_dwordx4 v5, s[44:47], s7 offen lds
    s_add_u32 s7, s7, 1024
    s_add_u32 m0, s11, 73728
    s_nop 0
    buffer_load_dwordx4 v4, s[44:47], s7 offen lds
    s_add_u32 m0, s11, 74752
    s_nop 0
    buffer_load_dwordx4 v5, s[44:47], s7 offen lds
    s_add_u32 s7, s7, 1024
    s_add_u32 m0, s11, 81920
    s_nop 0
    buffer_load_dwordx4 v4, s[44:47], s7 offen lds
    s_add_u32 m0, s11, 82944
    s_nop 0
    buffer_load_dwordx4 v5, s[44:47], s7 offen lds
    s_add_u32 s13, s13, 196608
    s_cmp_eq_u32 s13, 1572864
    s_cselect_b32 s13, 0, s13
    s_add_u32 m0, s11, 0
    s_nop 0
    buffer_load_dwordx4 v2, s[40:43], s12 offen lds
    s_add_u32 m0, s11, 1024
    s_nop 0
    buffer_load_dwordx4 v3, s[40:43], s12 offen lds
    s_add_u32 s12, s12, 128
    s_and_b32 s12, s12, 1023
    s_mov_b32 s7, s13
    s_add_u32 m0, s11, 90112
    s_nop 0
    buffer_load_dwordx4 v4, s[44:47], s7 offen lds
    s_add_u32 m0, s11, 91136
    s_nop 0
    buffer_load_dwordx4 v5, s[44:47], s7 offen lds
    s_add_u32 s7, s7, 1024
    s_add_u32 m0, s11, 98304
    s_nop 0
    buffer_load_dwordx4 v4, s[44:47], s7 offen lds
    s_add_u32 m0, s11, 99328
    s_nop 0
    buffer_load_dwordx4 v5, s[44:47], s7 offen lds
    s_add_u32 s7, s7, 1024
    s_add_u32 m0, s11, 106496
    s_nop 0
    buffer_load_dwordx4 v4, s[44:47], s7 offen lds
    s_add_u32 m0, s11, 107520
    s_nop 0
    buffer_load_dwordx4 v5, s[44:47], s7 offen lds
    s_add_u32 s13, s13, 196608
    s_cmp_eq_u32 s13, 1572864
    s_cselect_b32 s13, 0, s13
    s_add_u32 m0, s11, 8192
    s_nop 0
    buffer_load_dwordx4 v2, s[40:43], s12 offen lds
    s_add_u32 m0, s11, 9216
    s_nop 0
    buffer_load_dwordx4 v3, s[40:43], s12 offen lds
    s_add_u32 s12, s12, 128
    s_and_b32 s12, s12, 1023
    s_waitcnt vmcnt(8)
    s_barrier
    s_add_u32 m0, s11, 16384
    s_nop 0
    buffer_load_dwordx4 v2, s[40:43], s12 offen lds
    s_add_u32 m0, s11, 17408
    s_nop 0
    buffer_load_dwordx4 v3, s[40:43], s12 offen lds
    s_add_u32 s12, s12, 128
    s_and_b32 s12, s12, 1023
    s_mov_b32 s7, s13
    s_add_u32 m0, s11, 131072
    s_nop 0
    buffer_load_dwordx4 v4, s[44:47], s7 offen lds
    s_add_u32 m0, s11, 132096
    s_nop 0
    buffer_load_dwordx4 v5, s[44:47], s7 offen lds
    s_add_u32 s7, s7, 1024
    s_add_u32 m0, s11, 139264
    s_nop 0
    buffer_load_dwordx4 v4, s[44:47], s7 offen lds
    s_add_u32 m0, s11, 140288
    s_nop 0
    buffer_load_dwordx4 v5, s[44:47], s7 offen lds
    s_add_u32 s7, s7, 1024
    s_add_u32 m0, s11, 147456
    s_nop 0
    buffer_load_dwordx4 v4, s[44:47], s7 offen lds
    s_add_u32 m0, s11, 148480
    s_nop 0
    buffer_load_dwordx4 v5, s[44:47], s7 offen lds
    s_add_u32 s13, s13, 196608
    s_cmp_eq_u32 s13, 1572864
    s_cselect_b32 s13, 0, s13
    s_add_u32 m0, s11, 24576
    s_nop 0
    buffer_load_dwordx4 v2, s[40:43], s12 offen lds
    s_add_u32 m0, s11, 25600
    s_nop 0
    buffer_load_dwordx4 v3, s[40:43], s12 offen lds
    s_add_u32 s12, s12, 128
    s_and_b32 s12, s12, 1023
    s_waitcnt vmcnt(10)
    s_barrier
    s_add_u32 m0, s11, 32768
    s_nop 0
    buffer_load_dwordx4 v2, s[40:43], s12 offen lds
    s_add_u32 m0, s11, 33792
    s_nop 0
    buffer_load_dwordx4 v3, s[40:43], s12 offen lds
    s_add_u32 s12, s12, 128
    s_and_b32 s12, s12, 1023
    s_add_u32 m0, s11, 40960
    s_nop 0
    buffer_load_dwordx4 v2, s[40:43], s12 offen lds
    s_add_u32 m0, s11, 41984
    s_nop 0
    buffer_load_dwordx4 v3, s[40:43], s12 offen lds
    s_add_u32 s12, s12, 128
    s_and_b32 s12, s12, 1023
    s_mov_b32 s7, s13
    s_add_u32 m0, s11, 65536
    s_nop 0
    buffer_load_dwordx4 v4, s[44:47], s7 offen lds
    s_add_u32 m0, s11, 66560
    s_nop 0
    buffer_load_dwordx4 v5, s[44:47], s7 offen lds
    s_add_u32 s7, s7, 1024
    s_add_u32 m0, s11, 73728
    s_nop 0
    buffer_load_dwordx4 v4, s[44:47], s7 offen lds
    s_add_u32 m0, s11, 74752
    s_nop 0
    buffer_load_dwordx4 v5, s[44:47], s7 offen lds
    s_add_u32 s7, s7, 1024
    s_add_u32 m0, s11, 81920
    s_nop 0
    buffer_load_dwordx4 v4, s[44:47], s7 offen lds
    s_add_u32 m0, s11, 82944
    s_nop 0
    buffer_load_dwordx4 v5, s[44:47], s7 offen lds
    s_add_u32 s13, s13, 196608
    s_cmp_eq_u32 s13, 1572864
    s_cselect_b32 s13, 0, s13
    s_waitcnt vmcnt(12)
    s_barrier
    s_add_u32 m0, s11, 49152
    s_nop 0
    buffer_load_dwordx4 v2, s[40:43], s12 offen lds
    s_add_u32 m0, s11, 50176
    s_nop 0
    buffer_load_dwordx4 v3, s[40:43], s12 offen lds
    s_add_u32 s12, s12, 128
    s_and_b32 s12, s12, 1023
    s_add_u32 m0, s11, 57344
    s_nop 0
    buffer_load_dwordx4 v2, s[40:43], s12 offen lds
    s_add_u32 m0, s11, 58368
    s_nop 0
    buffer_load_dwordx4 v3, s[40:43], s12 offen lds
    s_add_u32 s12, s12, 128
    s_and_b32 s12, s12, 1023
    s_mov_b32 s7, s13
    s_add_u32 m0, s11, 90112
    s_nop 0
    buffer_load_dwordx4 v4, s[44:47], s7 offen lds
    s_add_u32 m0, s11, 91136
    s_nop 0
    buffer_load_dwordx4 v5, s[44:47], s7 offen lds
    s_add_u32 s7, s7, 1024
    s_add_u32 m0, s11, 98304
    s_nop 0
    buffer_load_dwordx4 v4, s[44:47], s7 offen lds
    s_add_u32 m0, s11, 99328
    s_nop 0
    buffer_load_dwordx4 v5, s[44:47], s7 offen lds
    s_add_u32 s7, s7, 1024
    s_add_u32 m0, s11, 106496
    s_nop 0
    buffer_load_dwordx4 v4, s[44:47], s7 offen lds
    s_add_u32 m0, s11, 107520
    s_nop 0
    buffer_load_dwordx4 v5, s[44:47], s7 offen lds
    s_add_u32 s13, s13, 196608
    s_cmp_eq_u32 s13, 1572864
    s_cselect_b32 s13, 0, s13
    s_waitcnt vmcnt(10)
    s_barrier
    s_mov_b32 s7, s13
    s_add_u32 m0, s11, 131072
    s_nop 0
    buffer_load_dwordx4 v4, s[44:47], s7 offen lds
    s_add_u32 m0, s11, 132096
    s_nop 0
    buffer_load_dwordx4 v5, s[44:47], s7 offen lds
    s_add_u32 s7, s7, 1024
    s_add_u32 m0, s11, 139264
    s_nop 0
    buffer_load_dwordx4 v4, s[44:47], s7 offen lds
    s_add_u32 m0, s11, 140288
    s_nop 0
    buffer_load_dwordx4 v5, s[44:47], s7 offen lds
    s_add_u32 s7, s7, 1024
    s_add_u32 m0, s11, 147456
    s_nop 0
    buffer_load_dwordx4 v4, s[44:47], s7 offen lds
    s_add_u32 m0, s11, 148480
    s_nop 0
    buffer_load_dwordx4 v5, s[44:47], s7 offen lds
    s_add_u32 s13, s13, 196608
    s_cmp_eq_u32 s13, 1572864
    s_cselect_b32 s13, 0, s13
    s_mov_b32 s7, s13
    s_add_u32 m0, s11, 0
    s_nop 0
    buffer_load_dwordx4 v4, s[44:47], s7 offen lds
    s_add_u32 m0, s11, 1024
    s_nop 0
    buffer_load_dwordx4 v5, s[44:47], s7 offen lds
    s_add_u32 s7, s7, 1024
    s_add_u32 m0, s11, 8192
    s_nop 0
    buffer_load_dwordx4 v4, s[44:47], s7 offen lds
    s_add_u32 m0, s11, 9216
    s_nop 0
    buffer_load_dwordx4 v5, s[44:47], s7 offen lds
    s_add_u32 s7, s7, 1024
    s_add_u32 m0, s11, 16384
    s_nop 0
    buffer_load_dwordx4 v4, s[44:47], s7 offen lds
    s_add_u32 m0, s11, 17408
    s_nop 0
    buffer_load_dwordx4 v5, s[44:47], s7 offen lds
    s_add_u32 s13, s13, 196608
    s_cmp_eq_u32 s13, 1572864
    s_cselect_b32 s13, 0, s13
    s_waitcnt vmcnt(12)
    s_barrier
    s_mov_b32 s7, s13
    s_add_u32 m0, s11, 65536
    s_nop 0
    buffer_load_dwordx4 v4, s[44:47], s7 offen lds
    s_add_u32 m0, s11, 66560
    s_nop 0
    buffer_load_dwordx4 v5, s[44:47], s7 offen lds
    s_add_u32 s7, s7, 1024
    s_add_u32 m0, s11, 73728
    s_nop 0
    buffer_load_dwordx4 v4, s[44:47], s7 offen lds
    s_add_u32 m0, s11, 74752
    s_nop 0
    buffer_load_dwordx4 v5, s[44:47], s7 offen lds
    s_add_u32 s7, s7, 1024
    s_add_u32 m0, s11, 81920
    s_nop 0
    buffer_load_dwordx4 v4, s[44:47], s7 offen lds
    s_add_u32 m0, s11, 82944
    s_nop 0
    buffer_load_dwordx4 v5, s[44:47], s7 offen lds
    s_add_u32 s13, s13, 196608
    s_cmp_eq_u32 s13, 1572864
    s_cselect_b32 s13, 0, s13
    s_mov_b32 s48, s24
    s_mov_b32 s49, s25
    s_mov_b32 s50, 0x700000
    s_mov_b32 s51, 0x20000
    v_lshlrev_b32 v6, 4, v0
    s_mul_i32 s14, s10, 1835008
    s_mul_i32 s6, s2, 896
    s_add_u32 s14, s14, s6
    s_mov_b32 exec_hi, 0xffffff
    buffer_load_dwordx4 v[116:119], v6, s[48:51], s14 offen
    s_mov_b64 exec, -1
    s_add_u32 s14, s14, 229376
    s_mov_b32 exec_hi, 0xffffff
    buffer_load_dwordx4 v[116:119], v6, s[48:51], s14 offen
    s_mov_b64 exec, -1
    s_add_u32 s14, s14, 229376
    s_waitcnt vmcnt(14)
    s_barrier
    s_cmp_lg_u32 s3, 5
    s_cbranch_scc1 L_cp_1
    s_getpc_b64 s[52:53]
L_cph_2:
    s_sub_u32 s52, s52, L_cph_2 - gated_mix__softmax_full_mha__mixer_token_mlp__prompt_kernel
    s_subb_u32 s53, s53, 0
    s_mov_b32 s54, L_end - gated_mix__softmax_full_mha__mixer_token_mlp__prompt_kernel
    s_mov_b32 s55, 0x20000
    s_lshl_b32 s6, s5, 10
    v_lshlrev_b32_e64 v7, 6, v0
    s_mov_b64 exec, 0xffff
    buffer_load_dword v115, v7, s[52:55], s6 offen
    s_mov_b64 exec, -1
L_cp_1:
    s_mov_b32 exec_hi, 0xffffff
    buffer_load_dwordx4 v[116:119], v6, s[48:51], s14 offen
    s_mov_b64 exec, -1
    s_add_u32 s14, s14, 229376
    s_mov_b32 exec_hi, 0xffffff
    buffer_load_dwordx4 v[116:119], v6, s[48:51], s14 offen
    s_mov_b64 exec, -1
    s_add_u32 s14, s14, 229376
    s_waitcnt vmcnt(10)
    s_barrier
    s_waitcnt vmcnt(4)
    s_barrier
    s_add_u32 s56, s38, 0xc80000
    s_addc_u32 s57, s39, 0
    s_mov_b32 s58, 0x20100
    s_mov_b32 s59, 0x20000
    v_mov_b32 v4, 155760
    ds_read_b32 v4, v4
    s_waitcnt lgkmcnt(0)
    v_readfirstlane_b32 s71, v4
    s_lshl_b32 s8, s4, 2
    s_and_b32 s6, s5, 3
    s_add_u32 s8, s8, s6
    s_lshr_b32 s9, s5, 2
    s_lshl_b32 s9, s9, 3
    s_add_u32 s9, s9, s3
    v_lshlrev_b32 v109, 4, v0
    v_and_b32 v3, 15, v0
    v_lshrrev_b32 v4, 5, v0
    v_lshlrev_b32 v4, 8, v4
    v_lshl_add_u32 v3, v3, 4, v4
    v_add_u32 v110, 65536, v3
    v_and_b32 v3, 7, v0
    v_lshlrev_b32 v3, 2, v3
    v_add_u32 v2, 155648, v3
    v_mov_b32 v48, 0
    v_mov_b32 v92, 0
    v_mov_b32 v49, 0
    v_mov_b32 v93, 0
    v_mov_b32 v50, 0
    v_mov_b32 v94, 0
    v_mov_b32 v51, 0
    v_mov_b32 v95, 0
    v_mov_b32 v52, 0
    v_mov_b32 v96, 0
    v_mov_b32 v53, 0
    v_mov_b32 v97, 0
    v_mov_b32 v54, 0
    v_mov_b32 v98, 0
    v_mov_b32 v55, 0
    v_mov_b32 v99, 0
    v_mov_b32 v56, 0
    v_mov_b32 v100, 0
    v_mov_b32 v57, 0
    v_mov_b32 v101, 0
    v_mov_b32 v58, 0
    v_mov_b32 v102, 0
    v_mov_b32 v59, 0
    v_mov_b32 v103, 0
    v_mov_b32 v60, 0
    v_mov_b32 v104, 0
    v_mov_b32 v61, 0
    v_mov_b32 v105, 0
    v_mov_b32 v62, 0
    v_mov_b32 v106, 0
    v_mov_b32 v63, 0
    v_mov_b32 v107, 0
    v_mov_b32 v40, 0
    v_mov_b32 v41, 0
    v_mov_b32 v42, 0
    v_mov_b32 v43, 0
    v_mov_b32 v44, 0
    v_mov_b32 v45, 0
    v_mov_b32 v46, 0
    v_mov_b32 v47, 0
    s_mov_b32 exec_lo, 0x110000
    s_mov_b32 exec_hi, 0x110000
    v_mov_b32 v92, 0x3f803f80
    v_mov_b32 v93, 0x3f803f80
    v_mov_b32 v94, 0x3f803f80
    v_mov_b32 v95, 0x3f803f80
    v_mov_b32 v96, 0x3f803f80
    v_mov_b32 v97, 0x3f803f80
    v_mov_b32 v98, 0x3f803f80
    v_mov_b32 v99, 0x3f803f80
    v_mov_b32 v100, 0x3f803f80
    v_mov_b32 v101, 0x3f803f80
    v_mov_b32 v102, 0x3f803f80
    v_mov_b32 v103, 0x3f803f80
    v_mov_b32 v104, 0x3f803f80
    v_mov_b32 v105, 0x3f803f80
    v_mov_b32 v106, 0x3f803f80
    v_mov_b32 v107, 0x3f803f80
    s_mov_b64 exec, -1
    s_nop 0
    v_mov_b32 v108, 0xdddddddd
    s_add_u32 s40, s38, 0x10000
    s_addc_u32 s41, s39, 0
    s_mov_b32 s42, 0x630000
    s_mov_b32 s43, 0x20000
    s_add_u32 s44, s38, 0xa60000
    s_addc_u32 s45, s39, 0
    s_mov_b32 s46, 0x200000
    s_mov_b32 s47, 0x20000
    s_and_b32 s11, s3, 3
    s_lshl_b32 s11, s11, 10
    s_lshl_b32 s54, s8, 16
    s_add_u32 s54, s54, 0x210000
    s_add_u32 s55, s54, 0x210000
    s_mov_b32 s64, 0
    s_lshl_b32 s64, s64, 13
    s_add_u32 s64, s64, s11
    s_add_u32 s64, s64, 0
    s_and_b32 s64, s64, 0xffff
    s_lshl_b32 s15, s3, 2
    s_add_u32 s15, s15, 155648
    v_mov_b32 v111, s15
    s_setprio 3
    s_lshl_b32 s48, s8, 16
    s_lshl_b32 s7, s9, 10
    s_add_u32 s48, s48, s7
    s_mov_b32 s16, s20
    s_mov_b32 s17, s21
    s_mov_b32 s18, 0x80000
    s_mov_b32 s19, 0x20000
    v_lshrrev_b32 v7, 3, v0
    v_lshlrev_b32_e64 v112, 10, v7
    v_bfe_u32 v7, v0, 4, 1
    v_lshlrev_b32 v7, 2, v7
    v_and_b32 v8, 7, v0
    v_xor_b32_e64 v7, v7, v8
    v_lshl_add_u32 v112, v7, 4, v112
    s_lshl_b32 s6, s3, 16
    s_and_b32 s7, s5, 7
    s_lshl_b32 s7, s7, 7
    s_add_u32 s61, s6, s7
    s_movk_i32 s60, 6
    s_nop 0
    v_mov_b32 v9, 155700
    s_cmp_lg_u32 s3, 4
    s_cbranch_scc1 L_np_3
    v_lshlrev_b32 v7, 4, v0
    s_lshl_b32 s7, s4, 9
    s_and_b32 s6, s5, 3
    s_lshl_b32 s6, s6, 14
    s_add_u32 s7, s7, s6
    s_add_u32 s7, s7, 8192
    v_mov_b32 v13, 0
    v_mov_b32_e64 v14, 0
    v_mov_b32 v8, 155696
L_w_6:
    ds_read_b32 v3, v8
    s_waitcnt lgkmcnt(0)
    v_cmp_le_u32 vcc, 4, v3
    s_cmp_eq_u64 vcc, -1
    s_cbranch_scc1 L_wd_7
    s_sleep 1
    s_sub_u32 s70, s70, 1
    s_cmp_gt_i32 s70, 0
    s_cbranch_scc1 L_w_6
L_wd_7:
    s_mov_b32 exec_hi, 0
L_gp_4:
    buffer_load_dwordx4 v[12:15], v7, s[56:59], s7 offen sc1
    s_waitcnt vmcnt(0)
    v_xor_b32 v12, s71, v12
    v_xor_b32 v15, s71, v15
    v_or_b32_e64 v12, v12, v15
    v_cmp_eq_u32 vcc, 0, v12
    s_cmp_eq_u32 vcc_lo, -1
    s_cbranch_scc1 L_gpd_5
    s_sleep 1
    s_sub_u32 s70, s70, 1
    s_cmp_gt_i32 s70, 0
    s_cbranch_scc1 L_gp_4
L_gpd_5:
    s_mov_b64 exec, -1
    v_mov_b32 v8, 1
    ds_write_b32 v9, v8
L_np_3:
L_w_8:
    ds_read_b32 v8, v9
    s_waitcnt lgkmcnt(0)
    v_cmp_le_u32 vcc, 1, v8
    s_cmp_eq_u64 vcc, -1
    s_cbranch_scc1 L_wd_9
    s_sleep 1
    s_sub_u32 s70, s70, 1
    s_cmp_gt_i32 s70, 0
    s_cbranch_scc1 L_w_8
L_wd_9:
    s_add_u32 m0, s11, 0
    s_add_u32 s6, s54, s64
    buffer_load_dwordx4 v109, s[40:43], s6 offen sc1 lds
    s_add_u32 m0, s11, 65536
    s_add_u32 s6, s55, s64
    buffer_load_dwordx4 v109, s[40:43], s6 offen sc1 lds
    s_add_u32 s64, s64, 4096
    s_and_b32 s64, s64, 0xffff
    buffer_load_dwordx4 v[80:83], v109, s[40:43], s48 offen sc1
    s_add_u32 m0, s11, 4096
    s_add_u32 s6, s54, s64
    buffer_load_dwordx4 v109, s[40:43], s6 offen sc1 lds
    s_add_u32 m0, s11, 69632
    s_add_u32 s6, s55, s64
    buffer_load_dwordx4 v109, s[40:43], s6 offen sc1 lds
    s_add_u32 s64, s64, 4096
    s_and_b32 s64, s64, 0xffff
    s_add_u32 m0, s11, 8192
    s_add_u32 s6, s54, s64
    buffer_load_dwordx4 v109, s[40:43], s6 offen sc1 lds
    s_add_u32 m0, s11, 73728
    s_add_u32 s6, s55, s64
    buffer_load_dwordx4 v109, s[40:43], s6 offen sc1 lds
    s_add_u32 s64, s64, 4096
    s_and_b32 s64, s64, 0xffff
    s_cmp_lg_u32 s3, 4
    s_cbranch_scc1 L_nm_10
    v_max_f32_dpp v13, v13, v13 quad_perm:[1,0,3,2] row_mask:0xf bank_mask:0xf
    v_max_f32_dpp v14, v14, v14 quad_perm:[1,0,3,2] row_mask:0xf bank_mask:0xf
    s_nop 0
    s_nop 0
    v_max_f32_dpp v13, v13, v13 quad_perm:[2,3,0,1] row_mask:0xf bank_mask:0xf
    v_max_f32_dpp v14, v14, v14 quad_perm:[2,3,0,1] row_mask:0xf bank_mask:0xf
    s_nop 0
    s_nop 0
    v_max_f32_dpp v13, v13, v13 row_half_mirror row_mask:0xf bank_mask:0xf
    v_max_f32_dpp v14, v14, v14 row_half_mirror row_mask:0xf bank_mask:0xf
    s_nop 0
    s_nop 0
    v_max_f32_dpp v13, v13, v13 row_mirror row_mask:0xf bank_mask:0xf
    v_max_f32_dpp v14, v14, v14 row_mirror row_mask:0xf bank_mask:0xf
    s_nop 0
    s_nop 0
    v_permlane16_swap_b32 v13, v14
    v_max_f32 v13, v13, v14
    v_mov_b32 v14, v13
    s_nop 1
    v_permlane32_swap_b32 v13, v14
    v_max_f32 v13, v13, v14
    v_mov_b32 v9, 155744
    v_readlane_b32 s6, v13, 16
    s_nop 1
    v_mul_f32 v13, s6, v13
    v_cmp_ge_f32 vcc, 0x45100000, v13
    s_bitcmp1_b32 vcc_lo, 0
    s_cselect_b32 s6, 1, 2
    v_mov_b32 v8, s6
    ds_write_b32 v9, v8
L_nm_10:
    v_mov_b32 v3, 3
    s_waitcnt vmcnt(0)
    ds_write_b32 v111, v3
    s_mov_b32 s63, 1
    s_branch L_attn
L_cons:
    v_and_b32 v12, 31, v0
    v_lshrrev_b32 v13, 5, v0
    v_and_b32 v14, 0x13, v12
    v_and_b32_e64 v15, 4, v12
    v_lshl_or_b32 v14, v15, 1, v14
    v_and_b32 v15, 8, v12
    v_lshrrev_b32 v15, 1, v15
    v_or_b32 v14, v14, v15
    v_lshrrev_b32 v15, 1, v14
    v_and_b32 v15, 7, v15
    v_xor_b32 v15, v15, v13
    s_lshr_b32 s6, s3, 1
    s_lshl_b32 s6, s6, 5
    v_add_u32 v112, s6, v14
    v_lshlrev_b32 v112, 7, v112
    v_xor_b32_e64 v113, 0, v15
    v_lshl_add_u32 v2, v113, 4, v112
    v_xor_b32_e64 v113, 2, v15
    v_lshl_add_u32 v3, v113, 4, v112
    v_xor_b32_e64 v113, 4, v15
    v_lshl_add_u32 v4, v113, 4, v112
    v_xor_b32_e64 v113, 6, v15
    v_lshl_add_u32 v5, v113, 4, v112
    v_bfe_u32 v113, v0, 2, 2
    v_lshl_add_u32 v112, v13, 3, v113
    v_lshlrev_b32_e64 v112, 7, v112
    v_bfe_u32 v113, v0, 4, 1
    v_lshl_add_u32 v112, v113, 5, v112
    v_and_b32_e64 v113, 1, v0
    v_lshl_add_u32 v112, v113, 4, v112
    v_bfe_u32 v113, v0, 1, 1
    v_lshl_add_u32 v112, v113, 3, v112
    v_bfe_u32 v113, v0, 3, 1
    s_and_b32 s6, s3, 1
    v_xor_b32 v113, s6, v113
    v_lshl_add_u32 v112, v113, 6, v112
    v_mov_b32_e64 v6, v112
    v_add_u32 v10, 65536, v112
    v_add_u32 v11, 65536, v10
    s_waitcnt lgkmcnt(0)
    s_add_u32 s40, s38, 0x10000
    s_addc_u32 s41, s39, 0
    s_mov_b32 s42, 0x630000
    s_mov_b32 s43, 0x20000
    s_add_u32 s56, s38, 0xc80000
    s_addc_u32 s57, s39, 0
    s_mov_b32 s58, 0x20100
    s_mov_b32 s59, 0x20000
    s_lshl_b32 s6, s4, 1
    s_and_b32 s7, s3, 1
    s_add_u32 s6, s6, s7
    s_lshl_b32 s10, s6, 17
    s_lshl_b32 s6, s5, 1
    s_lshr_b32 s7, s3, 1
    s_add_u32 s6, s6, s7
    s_lshl_b32 s6, s6, 10
    s_add_u32 s10, s10, s6
    v_lshlrev_b32_e64 v114, 9, v13
    v_lshl_add_u32 v114, v14, 4, v114
    v_lshrrev_b32 v115, 4, v12
    v_lshlrev_b32 v115, 16, v115
    v_lshl_add_u32 v115, v13, 8, v115
    v_and_b32_e64 v113, 15, v12
    v_lshl_add_u32 v115, v113, 4, v115
    s_mov_b32 s13, 0x3eb8aa3b
    s_add_u32 s11, s10, 2162688
    s_add_u32 s12, s10, 4325376
    s_add_u32 s14, s10, 0x10000
    s_add_u32 s15, s11, 0x10000
    s_lshl_b32 s6, s4, 9
    s_lshl_b32 s7, s5, 4
    s_add_u32 s49, s6, s7
    s_add_u32 s49, s49, 8192
    s_nop 0
    v_mov_b32 v116, 155760
    v_lshrrev_b32_e64 v117, 2, v0
    v_add_u32 v117, 155776, v117
    s_barrier
    ds_read_b128 v[64:67], v2 offset:0
    ds_read_b64_tr_b16 v[68:69], v10 offset:0
    ds_read_b64_tr_b16 v[70:71], v10 offset:512
    ds_read_b64_tr_b16 v[72:73], v10 offset:8192
    ds_read_b64_tr_b16 v[74:75], v10 offset:8704
    ds_read_b64_tr_b16 v[76:77], v10 offset:16384
    ds_read_b64_tr_b16 v[78:79], v10 offset:16896
    ds_read_b128 v[80:83], v3 offset:0
    ds_read_b64_tr_b16 v[84:85], v10 offset:2048
    ds_read_b64_tr_b16 v[86:87], v10 offset:2560
    ds_read_b64_tr_b16 v[88:89], v10 offset:10240
    ds_read_b64_tr_b16 v[90:91], v10 offset:10752
    ds_read_b64_tr_b16 v[92:93], v10 offset:18432
    ds_read_b64_tr_b16 v[94:95], v10 offset:18944
    s_waitcnt lgkmcnt(7)
    v_mfma_f32_32x32x16_bf16 v[16:31], v[68:71], v[64:67], 0
    ds_read_b128 v[96:99], v4 offset:0
    ds_read_b64_tr_b16 v[100:101], v10 offset:4096
    ds_read_b64_tr_b16 v[102:103], v10 offset:4608
    v_mfma_f32_32x32x16_bf16 v[32:47], v[72:75], v[64:67], 0
    ds_read_b64_tr_b16 v[104:105], v10 offset:12288
    ds_read_b64_tr_b16 v[106:107], v10 offset:12800
    v_mfma_f32_32x32x16_bf16 v[48:63], v[64:67], v[76:79], 0
    ds_read_b64_tr_b16 v[108:109], v10 offset:20480
    ds_read_b64_tr_b16 v[110:111], v10 offset:20992
    s_waitcnt lgkmcnt(7)
    s_nop 0
    v_mfma_f32_32x32x16_bf16 v[16:31], v[84:87], v[80:83], v[16:31]
    ds_read_b128 v[64:67], v5 offset:0
    ds_read_b64_tr_b16 v[68:69], v10 offset:6144
    ds_read_b64_tr_b16 v[70:71], v10 offset:6656
    v_mfma_f32_32x32x16_bf16 v[32:47], v[88:91], v[80:83], v[32:47]
    ds_read_b64_tr_b16 v[72:73], v10 offset:14336
    ds_read_b64_tr_b16 v[74:75], v10 offset:14848
    v_mfma_f32_32x32x16_bf16 v[48:63], v[80:83], v[92:95], v[48:63]
    ds_read_b64_tr_b16 v[76:77], v10 offset:22528
    ds_read_b64_tr_b16 v[78:79], v10 offset:23040
    s_waitcnt lgkmcnt(0)
    s_barrier
    v_mfma_f32_32x32x16_bf16 v[16:31], v[100:103], v[96:99], v[16:31]
    ds_read_b128 v[80:83], v2 offset:8192
    ds_read_b64_tr_b16 v[84:85], v10 offset:24576
    ds_read_b64_tr_b16 v[86:87], v10 offset:25088
    v_mfma_f32_32x32x16_bf16 v[32:47], v[104:107], v[96:99], v[32:47]
    ds_read_b64_tr_b16 v[88:89], v10 offset:32768
    ds_read_b64_tr_b16 v[90:91], v10 offset:33280
    v_mfma_f32_32x32x16_bf16 v[48:63], v[96:99], v[108:111], v[48:63]
    ds_read_b64_tr_b16 v[92:93], v10 offset:40960
    ds_read_b64_tr_b16 v[94:95], v10 offset:41472
    v_mfma_f32_32x32x16_bf16 v[16:31], v[68:71], v[64:67], v[16:31]
    ds_read_b128 v[96:99], v3 offset:8192
    ds_read_b64_tr_b16 v[100:101], v10 offset:26624
    ds_read_b64_tr_b16 v[102:103], v10 offset:27136
    v_mfma_f32_32x32x16_bf16 v[32:47], v[72:75], v[64:67], v[32:47]
    ds_read_b64_tr_b16 v[104:105], v10 offset:34816
    ds_read_b64_tr_b16 v[106:107], v10 offset:35328
    v_mfma_f32_32x32x16_bf16 v[48:63], v[64:67], v[76:79], v[48:63]
    ds_read_b64_tr_b16 v[108:109], v10 offset:43008
    ds_read_b64_tr_b16 v[110:111], v10 offset:43520
    s_waitcnt lgkmcnt(7)
    s_nop 0
    v_mfma_f32_32x32x16_bf16 v[16:31], v[84:87], v[80:83], v[16:31]
    ds_read_b128 v[64:67], v4 offset:8192
    ds_read_b64_tr_b16 v[68:69], v10 offset:28672
    ds_read_b64_tr_b16 v[70:71], v10 offset:29184
    v_mfma_f32_32x32x16_bf16 v[32:47], v[88:91], v[80:83], v[32:47]
    ds_read_b64_tr_b16 v[72:73], v10 offset:36864
    ds_read_b64_tr_b16 v[74:75], v10 offset:37376
    v_mfma_f32_32x32x16_bf16 v[48:63], v[80:83], v[92:95], v[48:63]
    ds_read_b64_tr_b16 v[76:77], v10 offset:45056
    ds_read_b64_tr_b16 v[78:79], v10 offset:45568
    s_waitcnt lgkmcnt(7)
    s_nop 0
    v_mfma_f32_32x32x16_bf16 v[16:31], v[100:103], v[96:99], v[16:31]
    ds_read_b128 v[80:83], v5 offset:8192
    ds_read_b64_tr_b16 v[84:85], v10 offset:30720
    ds_read_b64_tr_b16 v[86:87], v10 offset:31232
    v_mfma_f32_32x32x16_bf16 v[32:47], v[104:107], v[96:99], v[32:47]
    ds_read_b64_tr_b16 v[88:89], v10 offset:38912
    ds_read_b64_tr_b16 v[90:91], v10 offset:39424
    v_mfma_f32_32x32x16_bf16 v[48:63], v[96:99], v[108:111], v[48:63]
    ds_read_b64_tr_b16 v[92:93], v10 offset:47104
    ds_read_b64_tr_b16 v[94:95], v10 offset:47616
    s_waitcnt lgkmcnt(0)
    s_barrier
    v_mfma_f32_32x32x16_bf16 v[16:31], v[68:71], v[64:67], v[16:31]
    ds_read_b128 v[96:99], v2 offset:16384
    ds_read_b64_tr_b16 v[100:101], v11 offset:0
    ds_read_b64_tr_b16 v[102:103], v11 offset:512
    v_mfma_f32_32x32x16_bf16 v[32:47], v[72:75], v[64:67], v[32:47]
    ds_read_b64_tr_b16 v[104:105], v11 offset:8192
    ds_read_b64_tr_b16 v[106:107], v11 offset:8704
    v_mfma_f32_32x32x16_bf16 v[48:63], v[64:67], v[76:79], v[48:63]
    ds_read_b64_tr_b16 v[108:109], v11 offset:16384
    ds_read_b64_tr_b16 v[110:111], v11 offset:16896
    v_mfma_f32_32x32x16_bf16 v[16:31], v[84:87], v[80:83], v[16:31]
    ds_read_b128 v[64:67], v3 offset:16384
    ds_read_b64_tr_b16 v[68:69], v11 offset:2048
    ds_read_b64_tr_b16 v[70:71], v11 offset:2560
    v_mfma_f32_32x32x16_bf16 v[32:47], v[88:91], v[80:83], v[32:47]
    ds_read_b64_tr_b16 v[72:73], v11 offset:10240
    ds_read_b64_tr_b16 v[74:75], v11 offset:10752
    v_mfma_f32_32x32x16_bf16 v[48:63], v[80:83], v[92:95], v[48:63]
    ds_read_b64_tr_b16 v[76:77], v11 offset:18432
    ds_read_b64_tr_b16 v[78:79], v11 offset:18944
    s_waitcnt lgkmcnt(7)
    s_nop 0
    v_mfma_f32_32x32x16_bf16 v[16:31], v[100:103], v[96:99], v[16:31]
    ds_read_b128 v[80:83], v4 offset:16384
    ds_read_b64_tr_b16 v[84:85], v11 offset:4096
    ds_read_b64_tr_b16 v[86:87], v11 offset:4608
    v_mfma_f32_32x32x16_bf16 v[32:47], v[104:107], v[96:99], v[32:47]
    ds_read_b64_tr_b16 v[88:89], v11 offset:12288
    ds_read_b64_tr_b16 v[90:91], v11 offset:12800
    v_mfma_f32_32x32x16_bf16 v[48:63], v[96:99], v[108:111], v[48:63]
    ds_read_b64_tr_b16 v[92:93], v11 offset:20480
    ds_read_b64_tr_b16 v[94:95], v11 offset:20992
    s_waitcnt lgkmcnt(7)
    s_nop 0
    v_mfma_f32_32x32x16_bf16 v[16:31], v[68:71], v[64:67], v[16:31]
    ds_read_b128 v[96:99], v5 offset:16384
    ds_read_b64_tr_b16 v[100:101], v11 offset:6144
    ds_read_b64_tr_b16 v[102:103], v11 offset:6656
    v_mfma_f32_32x32x16_bf16 v[32:47], v[72:75], v[64:67], v[32:47]
    ds_read_b64_tr_b16 v[104:105], v11 offset:14336
    ds_read_b64_tr_b16 v[106:107], v11 offset:14848
    v_mfma_f32_32x32x16_bf16 v[48:63], v[64:67], v[76:79], v[48:63]
    ds_read_b64_tr_b16 v[108:109], v11 offset:22528
    ds_read_b64_tr_b16 v[110:111], v11 offset:23040
    s_waitcnt lgkmcnt(0)
    s_barrier
    v_mfma_f32_32x32x16_bf16 v[16:31], v[84:87], v[80:83], v[16:31]
    ds_read_b128 v[64:67], v2 offset:24576
    ds_read_b64_tr_b16 v[68:69], v10 offset:0
    ds_read_b64_tr_b16 v[70:71], v10 offset:512
    v_mfma_f32_32x32x16_bf16 v[32:47], v[88:91], v[80:83], v[32:47]
    ds_read_b64_tr_b16 v[72:73], v10 offset:8192
    ds_read_b64_tr_b16 v[74:75], v10 offset:8704
    v_mfma_f32_32x32x16_bf16 v[48:63], v[80:83], v[92:95], v[48:63]
    ds_read_b64_tr_b16 v[76:77], v10 offset:16384
    ds_read_b64_tr_b16 v[78:79], v10 offset:16896
    v_mfma_f32_32x32x16_bf16 v[16:31], v[100:103], v[96:99], v[16:31]
    ds_read_b128 v[80:83], v3 offset:24576
    ds_read_b64_tr_b16 v[84:85], v10 offset:2048
    ds_read_b64_tr_b16 v[86:87], v10 offset:2560
    v_mfma_f32_32x32x16_bf16 v[32:47], v[104:107], v[96:99], v[32:47]
    ds_read_b64_tr_b16 v[88:89], v10 offset:10240
    ds_read_b64_tr_b16 v[90:91], v10 offset:10752
    v_mfma_f32_32x32x16_bf16 v[48:63], v[96:99], v[108:111], v[48:63]
    ds_read_b64_tr_b16 v[92:93], v10 offset:18432
    ds_read_b64_tr_b16 v[94:95], v10 offset:18944
    s_waitcnt lgkmcnt(7)
    s_nop 0
    v_mfma_f32_32x32x16_bf16 v[16:31], v[68:71], v[64:67], v[16:31]
    ds_read_b128 v[96:99], v4 offset:24576
    ds_read_b64_tr_b16 v[100:101], v10 offset:4096
    ds_read_b64_tr_b16 v[102:103], v10 offset:4608
    v_mfma_f32_32x32x16_bf16 v[32:47], v[72:75], v[64:67], v[32:47]
    ds_read_b64_tr_b16 v[104:105], v10 offset:12288
    ds_read_b64_tr_b16 v[106:107], v10 offset:12800
    v_mfma_f32_32x32x16_bf16 v[48:63], v[64:67], v[76:79], v[48:63]
    ds_read_b64_tr_b16 v[108:109], v10 offset:20480
    ds_read_b64_tr_b16 v[110:111], v10 offset:20992
    s_waitcnt lgkmcnt(7)
    s_nop 0
    v_mfma_f32_32x32x16_bf16 v[16:31], v[84:87], v[80:83], v[16:31]
    ds_read_b128 v[64:67], v5 offset:24576
    ds_read_b64_tr_b16 v[68:69], v10 offset:6144
    ds_read_b64_tr_b16 v[70:71], v10 offset:6656
    v_mfma_f32_32x32x16_bf16 v[32:47], v[88:91], v[80:83], v[32:47]
    ds_read_b64_tr_b16 v[72:73], v10 offset:14336
    ds_read_b64_tr_b16 v[74:75], v10 offset:14848
    v_mfma_f32_32x32x16_bf16 v[48:63], v[80:83], v[92:95], v[48:63]
    ds_read_b64_tr_b16 v[76:77], v10 offset:22528
    ds_read_b64_tr_b16 v[78:79], v10 offset:23040
    s_waitcnt lgkmcnt(0)
    s_barrier
    v_mfma_f32_32x32x16_bf16 v[16:31], v[100:103], v[96:99], v[16:31]
    ds_read_b128 v[80:83], v2 offset:32768
    ds_read_b64_tr_b16 v[84:85], v10 offset:24576
    ds_read_b64_tr_b16 v[86:87], v10 offset:25088
    v_mfma_f32_32x32x16_bf16 v[32:47], v[104:107], v[96:99], v[32:47]
    ds_read_b64_tr_b16 v[88:89], v10 offset:32768
    ds_read_b64_tr_b16 v[90:91], v10 offset:33280
    v_mfma_f32_32x32x16_bf16 v[48:63], v[96:99], v[108:111], v[48:63]
    ds_read_b64_tr_b16 v[92:93], v10 offset:40960
    ds_read_b64_tr_b16 v[94:95], v10 offset:41472
    v_mfma_f32_32x32x16_bf16 v[16:31], v[68:71], v[64:67], v[16:31]
    ds_read_b128 v[96:99], v3 offset:32768
    ds_read_b64_tr_b16 v[100:101], v10 offset:26624
    ds_read_b64_tr_b16 v[102:103], v10 offset:27136
    v_mfma_f32_32x32x16_bf16 v[32:47], v[72:75], v[64:67], v[32:47]
    ds_read_b64_tr_b16 v[104:105], v10 offset:34816
    ds_read_b64_tr_b16 v[106:107], v10 offset:35328
    v_mfma_f32_32x32x16_bf16 v[48:63], v[64:67], v[76:79], v[48:63]
    ds_read_b64_tr_b16 v[108:109], v10 offset:43008
    ds_read_b64_tr_b16 v[110:111], v10 offset:43520
    s_waitcnt lgkmcnt(7)
    s_nop 0
    v_mfma_f32_32x32x16_bf16 v[16:31], v[84:87], v[80:83], v[16:31]
    ds_read_b128 v[64:67], v4 offset:32768
    ds_read_b64_tr_b16 v[68:69], v10 offset:28672
    ds_read_b64_tr_b16 v[70:71], v10 offset:29184
    v_mfma_f32_32x32x16_bf16 v[32:47], v[88:91], v[80:83], v[32:47]
    ds_read_b64_tr_b16 v[72:73], v10 offset:36864
    ds_read_b64_tr_b16 v[74:75], v10 offset:37376
    v_mfma_f32_32x32x16_bf16 v[48:63], v[80:83], v[92:95], v[48:63]
    ds_read_b64_tr_b16 v[76:77], v10 offset:45056
    ds_read_b64_tr_b16 v[78:79], v10 offset:45568
    s_waitcnt lgkmcnt(7)
    s_nop 0
    v_mfma_f32_32x32x16_bf16 v[16:31], v[100:103], v[96:99], v[16:31]
    ds_read_b128 v[80:83], v5 offset:32768
    ds_read_b64_tr_b16 v[84:85], v10 offset:30720
    ds_read_b64_tr_b16 v[86:87], v10 offset:31232
    v_mfma_f32_32x32x16_bf16 v[32:47], v[104:107], v[96:99], v[32:47]
    ds_read_b64_tr_b16 v[88:89], v10 offset:38912
    ds_read_b64_tr_b16 v[90:91], v10 offset:39424
    v_mfma_f32_32x32x16_bf16 v[48:63], v[96:99], v[108:111], v[48:63]
    ds_read_b64_tr_b16 v[92:93], v10 offset:47104
    ds_read_b64_tr_b16 v[94:95], v10 offset:47616
    s_waitcnt lgkmcnt(0)
    s_barrier
    v_mfma_f32_32x32x16_bf16 v[16:31], v[68:71], v[64:67], v[16:31]
    ds_read_b128 v[96:99], v2 offset:40960
    ds_read_b64_tr_b16 v[100:101], v11 offset:0
    ds_read_b64_tr_b16 v[102:103], v11 offset:512
    v_mfma_f32_32x32x16_bf16 v[32:47], v[72:75], v[64:67], v[32:47]
    ds_read_b64_tr_b16 v[104:105], v11 offset:8192
    ds_read_b64_tr_b16 v[106:107], v11 offset:8704
    v_mfma_f32_32x32x16_bf16 v[48:63], v[64:67], v[76:79], v[48:63]
    ds_read_b64_tr_b16 v[108:109], v11 offset:16384
    ds_read_b64_tr_b16 v[110:111], v11 offset:16896
    v_mfma_f32_32x32x16_bf16 v[16:31], v[84:87], v[80:83], v[16:31]
    ds_read_b128 v[64:67], v3 offset:40960
    ds_read_b64_tr_b16 v[68:69], v11 offset:2048
    ds_read_b64_tr_b16 v[70:71], v11 offset:2560
    v_mfma_f32_32x32x16_bf16 v[32:47], v[88:91], v[80:83], v[32:47]
    ds_read_b64_tr_b16 v[72:73], v11 offset:10240
    ds_read_b64_tr_b16 v[74:75], v11 offset:10752
    v_mfma_f32_32x32x16_bf16 v[48:63], v[80:83], v[92:95], v[48:63]
    ds_read_b64_tr_b16 v[76:77], v11 offset:18432
    ds_read_b64_tr_b16 v[78:79], v11 offset:18944
    s_waitcnt lgkmcnt(7)
    s_nop 0
    v_mfma_f32_32x32x16_bf16 v[16:31], v[100:103], v[96:99], v[16:31]
    ds_read_b128 v[80:83], v4 offset:40960
    ds_read_b64_tr_b16 v[84:85], v11 offset:4096
    ds_read_b64_tr_b16 v[86:87], v11 offset:4608
    v_mfma_f32_32x32x16_bf16 v[32:47], v[104:107], v[96:99], v[32:47]
    ds_read_b64_tr_b16 v[88:89], v11 offset:12288
    ds_read_b64_tr_b16 v[90:91], v11 offset:12800
    v_mfma_f32_32x32x16_bf16 v[48:63], v[96:99], v[108:111], v[48:63]
    ds_read_b64_tr_b16 v[92:93], v11 offset:20480
    ds_read_b64_tr_b16 v[94:95], v11 offset:20992
    s_waitcnt lgkmcnt(7)
    s_nop 0
    v_mfma_f32_32x32x16_bf16 v[16:31], v[68:71], v[64:67], v[16:31]
    ds_read_b128 v[96:99], v5 offset:40960
    ds_read_b64_tr_b16 v[100:101], v11 offset:6144
    ds_read_b64_tr_b16 v[102:103], v11 offset:6656
    v_mfma_f32_32x32x16_bf16 v[32:47], v[72:75], v[64:67], v[32:47]
    ds_read_b64_tr_b16 v[104:105], v11 offset:14336
    ds_read_b64_tr_b16 v[106:107], v11 offset:14848
    v_mfma_f32_32x32x16_bf16 v[48:63], v[64:67], v[76:79], v[48:63]
    ds_read_b64_tr_b16 v[108:109], v11 offset:22528
    ds_read_b64_tr_b16 v[110:111], v11 offset:23040
    s_waitcnt lgkmcnt(0)
    s_barrier
    v_mfma_f32_32x32x16_bf16 v[16:31], v[84:87], v[80:83], v[16:31]
    ds_read_b128 v[64:67], v2 offset:49152
    ds_read_b64_tr_b16 v[68:69], v6 offset:0
    ds_read_b64_tr_b16 v[70:71], v6 offset:512
    v_mfma_f32_32x32x16_bf16 v[32:47], v[88:91], v[80:83], v[32:47]
    ds_read_b64_tr_b16 v[72:73], v6 offset:8192
    ds_read_b64_tr_b16 v[74:75], v6 offset:8704
    v_mfma_f32_32x32x16_bf16 v[48:63], v[80:83], v[92:95], v[48:63]
    ds_read_b64_tr_b16 v[76:77], v6 offset:16384
    ds_read_b64_tr_b16 v[78:79], v6 offset:16896
    v_mfma_f32_32x32x16_bf16 v[16:31], v[100:103], v[96:99], v[16:31]
    ds_read_b128 v[80:83], v3 offset:49152
    ds_read_b64_tr_b16 v[84:85], v6 offset:2048
    ds_read_b64_tr_b16 v[86:87], v6 offset:2560
    v_mfma_f32_32x32x16_bf16 v[32:47], v[104:107], v[96:99], v[32:47]
    ds_read_b64_tr_b16 v[88:89], v6 offset:10240
    ds_read_b64_tr_b16 v[90:91], v6 offset:10752
    v_mfma_f32_32x32x16_bf16 v[48:63], v[96:99], v[108:111], v[48:63]
    ds_read_b64_tr_b16 v[92:93], v6 offset:18432
    ds_read_b64_tr_b16 v[94:95], v6 offset:18944
    s_waitcnt lgkmcnt(7)
    s_nop 0
    v_mfma_f32_32x32x16_bf16 v[16:31], v[68:71], v[64:67], v[16:31]
    ds_read_b128 v[96:99], v4 offset:49152
    ds_read_b64_tr_b16 v[100:101], v6 offset:4096
    ds_read_b64_tr_b16 v[102:103], v6 offset:4608
    v_mfma_f32_32x32x16_bf16 v[32:47], v[72:75], v[64:67], v[32:47]
    ds_read_b64_tr_b16 v[104:105], v6 offset:12288
    ds_read_b64_tr_b16 v[106:107], v6 offset:12800
    v_mfma_f32_32x32x16_bf16 v[48:63], v[64:67], v[76:79], v[48:63]
    ds_read_b64_tr_b16 v[108:109], v6 offset:20480
    ds_read_b64_tr_b16 v[110:111], v6 offset:20992
    s_waitcnt lgkmcnt(7)
    s_nop 0
    v_mfma_f32_32x32x16_bf16 v[16:31], v[84:87], v[80:83], v[16:31]
    ds_read_b128 v[64:67], v5 offset:49152
    ds_read_b64_tr_b16 v[68:69], v6 offset:6144
    ds_read_b64_tr_b16 v[70:71], v6 offset:6656
    v_mfma_f32_32x32x16_bf16 v[32:47], v[88:91], v[80:83], v[32:47]
    ds_read_b64_tr_b16 v[72:73], v6 offset:14336
    ds_read_b64_tr_b16 v[74:75], v6 offset:14848
    v_mfma_f32_32x32x16_bf16 v[48:63], v[80:83], v[92:95], v[48:63]
    ds_read_b64_tr_b16 v[76:77], v6 offset:22528
    ds_read_b64_tr_b16 v[78:79], v6 offset:23040
    s_waitcnt lgkmcnt(0)
    s_barrier
    v_mfma_f32_32x32x16_bf16 v[16:31], v[100:103], v[96:99], v[16:31]
    ds_read_b128 v[80:83], v2 offset:57344
    ds_read_b64_tr_b16 v[84:85], v10 offset:0
    ds_read_b64_tr_b16 v[86:87], v10 offset:512
    v_mfma_f32_32x32x16_bf16 v[32:47], v[104:107], v[96:99], v[32:47]
    ds_read_b64_tr_b16 v[88:89], v10 offset:8192
    ds_read_b64_tr_b16 v[90:91], v10 offset:8704
    v_mfma_f32_32x32x16_bf16 v[48:63], v[96:99], v[108:111], v[48:63]
    ds_read_b64_tr_b16 v[92:93], v10 offset:16384
    ds_read_b64_tr_b16 v[94:95], v10 offset:16896
    v_mfma_f32_32x32x16_bf16 v[16:31], v[68:71], v[64:67], v[16:31]
    ds_read_b128 v[96:99], v3 offset:57344
    ds_read_b64_tr_b16 v[100:101], v10 offset:2048
    ds_read_b64_tr_b16 v[102:103], v10 offset:2560
    v_mfma_f32_32x32x16_bf16 v[32:47], v[72:75], v[64:67], v[32:47]
    ds_read_b64_tr_b16 v[104:105], v10 offset:10240
    ds_read_b64_tr_b16 v[106:107], v10 offset:10752
    v_mfma_f32_32x32x16_bf16 v[48:63], v[64:67], v[76:79], v[48:63]
    ds_read_b64_tr_b16 v[108:109], v10 offset:18432
    ds_read_b64_tr_b16 v[110:111], v10 offset:18944
    s_waitcnt lgkmcnt(7)
    s_nop 0
    v_mfma_f32_32x32x16_bf16 v[16:31], v[84:87], v[80:83], v[16:31]
    ds_read_b128 v[64:67], v4 offset:57344
    ds_read_b64_tr_b16 v[68:69], v10 offset:4096
    ds_read_b64_tr_b16 v[70:71], v10 offset:4608
    v_mfma_f32_32x32x16_bf16 v[32:47], v[88:91], v[80:83], v[32:47]
    ds_read_b64_tr_b16 v[72:73], v10 offset:12288
    ds_read_b64_tr_b16 v[74:75], v10 offset:12800
    v_mfma_f32_32x32x16_bf16 v[48:63], v[80:83], v[92:95], v[48:63]
    ds_read_b64_tr_b16 v[76:77], v10 offset:20480
    ds_read_b64_tr_b16 v[78:79], v10 offset:20992
    s_waitcnt lgkmcnt(7)
    s_nop 0
    v_mfma_f32_32x32x16_bf16 v[16:31], v[100:103], v[96:99], v[16:31]
    ds_read_b128 v[80:83], v5 offset:57344
    ds_read_b64_tr_b16 v[84:85], v10 offset:6144
    ds_read_b64_tr_b16 v[86:87], v10 offset:6656
    v_mfma_f32_32x32x16_bf16 v[32:47], v[104:107], v[96:99], v[32:47]
    ds_read_b64_tr_b16 v[88:89], v10 offset:14336
    ds_read_b64_tr_b16 v[90:91], v10 offset:14848
    v_mfma_f32_32x32x16_bf16 v[48:63], v[96:99], v[108:111], v[48:63]
    ds_read_b64_tr_b16 v[92:93], v10 offset:22528
    ds_read_b64_tr_b16 v[94:95], v10 offset:23040
    s_waitcnt lgkmcnt(0)
    s_nop 0
    v_mfma_f32_32x32x16_bf16 v[16:31], v[68:71], v[64:67], v[16:31]
    v_mfma_f32_32x32x16_bf16 v[32:47], v[72:75], v[64:67], v[32:47]
    v_mfma_f32_32x32x16_bf16 v[48:63], v[64:67], v[76:79], v[48:63]
    v_mfma_f32_32x32x16_bf16 v[16:31], v[84:87], v[80:83], v[16:31]
    v_mfma_f32_32x32x16_bf16 v[32:47], v[88:91], v[80:83], v[32:47]
    v_mfma_f32_32x32x16_bf16 v[48:63], v[80:83], v[92:95], v[48:63]
    ds_read_b64 v[4:5], v116
    s_nop 9
    s_nop 0
    v_cvt_pk_bf16_f32 v72, v32, v33
    v_cvt_pk_bf16_f32 v73, v34, v35
    v_cvt_pk_bf16_f32 v74, v36, v37
    v_cvt_pk_bf16_f32 v75, v38, v39
    v_cvt_pk_bf16_f32 v76, v40, v41
    v_cvt_pk_bf16_f32 v77, v42, v43
    v_cvt_pk_bf16_f32 v78, v44, v45
    v_cvt_pk_bf16_f32 v79, v46, v47
    s_waitcnt lgkmcnt(0)
    v_readfirstlane_b32 s71, v4
    v_readfirstlane_b32 s67, v5
    s_nop 0
    v_cvt_pk_bf16_f32 v80, v48, v49
    v_cvt_pk_bf16_f32 v81, v50, v51
    v_cvt_pk_bf16_f32 v82, v52, v53
    v_cvt_pk_bf16_f32 v83, v54, v55
    v_cvt_pk_bf16_f32 v84, v56, v57
    v_cvt_pk_bf16_f32 v85, v58, v59
    v_cvt_pk_bf16_f32 v86, v60, v61
    v_cvt_pk_bf16_f32 v87, v62, v63
    s_cmp_eq_u32 s67, 0
    s_cbranch_scc1 L_sl_11
    buffer_store_dwordx4 v[72:75], v114, s[40:43], s11 offen
    buffer_store_dwordx4 v[76:79], v114, s[40:43], s15 offen
    buffer_store_dwordx4 v[80:83], v115, s[40:43], s12 offen
    buffer_store_dwordx4 v[84:87], v115, s[40:43], s12 offen offset:512
    s_branch L_sd_12
L_sl_11:
    buffer_store_dwordx4 v[72:75], v114, s[40:43], s11 offen sc1
    buffer_store_dwordx4 v[76:79], v114, s[40:43], s15 offen sc1
    buffer_store_dwordx4 v[80:83], v115, s[40:43], s12 offen sc1
    buffer_store_dwordx4 v[84:87], v115, s[40:43], s12 offen offset:512 sc1
L_sd_12:
    v_mul_f32 v16, s13, v16
    v_mul_f32 v17, s13, v17
    v_mul_f32 v18, s13, v18
    v_mul_f32 v19, s13, v19
    v_mul_f32 v20, s13, v20
    v_mul_f32 v21, s13, v21
    v_mul_f32 v22, s13, v22
    v_mul_f32 v23, s13, v23
    v_mul_f32 v24, s13, v24
    v_mul_f32 v25, s13, v25
    v_mul_f32 v26, s13, v26
    v_mul_f32 v27, s13, v27
    v_mul_f32 v28, s13, v28
    v_mul_f32 v29, s13, v29
    v_mul_f32 v30, s13, v30
    v_mul_f32_e64 v31, s13, v31
    v_cvt_pk_bf16_f32 v64, v16, v17
    v_cvt_pk_bf16_f32 v65, v18, v19
    v_cvt_pk_bf16_f32 v66, v20, v21
    v_cvt_pk_bf16_f32 v67, v22, v23
    v_cvt_pk_bf16_f32 v68, v24, v25
    v_cvt_pk_bf16_f32 v69, v26, v27
    v_cvt_pk_bf16_f32 v70, v28, v29
    v_cvt_pk_bf16_f32 v71, v30, v31
    s_cmp_eq_u32 s67, 0
    s_cbranch_scc1 L_sl_13
    buffer_store_dwordx4 v[64:67], v114, s[40:43], s10 offen
    buffer_store_dwordx4 v[68:71], v114, s[40:43], s14 offen
    s_branch L_sd_14
L_sl_13:
    buffer_store_dwordx4 v[64:67], v114, s[40:43], s10 offen sc1
    buffer_store_dwordx4 v[68:71], v114, s[40:43], s14 offen sc1
L_sd_14:
    v_mul_f32 v4, v16, v16
    v_mul_f32 v5, v24, v24
    v_fmac_f32 v4, v17, v17
    v_fmac_f32 v5, v25, v25
    v_fmac_f32 v4, v18, v18
    v_fmac_f32 v5, v26, v26
    v_fmac_f32 v4, v19, v19
    v_fmac_f32 v5, v27, v27
    v_fmac_f32 v4, v20, v20
    v_fmac_f32 v5, v28, v28
    v_fmac_f32 v4, v21, v21
    v_fmac_f32 v5, v29, v29
    v_fmac_f32 v4, v22, v22
    v_fmac_f32 v5, v30, v30
    v_fmac_f32 v4, v23, v23
    v_fmac_f32 v5, v31, v31
    v_mul_f32 v6, v32, v32
    v_mul_f32 v7, v40, v40
    v_fmac_f32 v6, v33, v33
    v_fmac_f32 v7, v41, v41
    v_fmac_f32 v6, v34, v34
    v_fmac_f32 v7, v42, v42
    v_fmac_f32 v6, v35, v35
    v_fmac_f32 v7, v43, v43
    v_fmac_f32 v6, v36, v36
    v_fmac_f32 v7, v44, v44
    v_fmac_f32 v6, v37, v37
    v_fmac_f32 v7, v45, v45
    v_fmac_f32 v6, v38, v38
    v_fmac_f32 v7, v46, v46
    v_fmac_f32 v6, v39, v39
    v_fmac_f32 v7, v47, v47
    s_nop 1
    v_permlane32_swap_b32 v4, v5
    v_permlane32_swap_b32 v6, v7
    v_add_f32_e64 v4, v4, v5
    v_add_f32 v5, v6, v7
    s_nop 1
    v_max_f32_dpp v4, v4, v4 quad_perm:[1,0,3,2] row_mask:0xf bank_mask:0xf
    v_max_f32_dpp v5, v5, v5 quad_perm:[1,0,3,2] row_mask:0xf bank_mask:0xf
    s_nop 0
    s_nop 0
    v_max_f32_dpp v4, v4, v4 quad_perm:[2,3,0,1] row_mask:0xf bank_mask:0xf
    v_max_f32_dpp v5, v5, v5 quad_perm:[2,3,0,1] row_mask:0xf bank_mask:0xf
    s_nop 0
    s_nop 0
    v_max_f32_dpp v4, v4, v4 row_half_mirror row_mask:0xf bank_mask:0xf
    v_max_f32_dpp v5, v5, v5 row_half_mirror row_mask:0xf bank_mask:0xf
    s_nop 0
    s_nop 0
    v_max_f32_dpp v4, v4, v4 row_mirror row_mask:0xf bank_mask:0xf
    v_max_f32_dpp v5, v5, v5 row_mirror row_mask:0xf bank_mask:0xf
    s_nop 0
    s_nop 0
    v_permlane16_swap_b32 v4, v5
    v_max_f32 v4, v4, v5
    v_mov_b32_e64 v5, v4
    s_nop 1
    v_permlane32_swap_b32 v4, v5
    v_max_f32 v4, v4, v5
    s_mov_b64 exec, 0x10001
    ds_max_u32 v117, v4
    s_mov_b64 exec, 1
    v_mov_b32 v4, 155696
    v_mov_b32_e64 v5, 1
    v_mov_b32 v6, 155776
    s_waitcnt vmcnt(0)
    ds_add_rtn_u32 v5, v4, v5
    ds_read_b64 v[10:11], v6
    s_waitcnt lgkmcnt(0)
    s_mov_b64 exec, -1
    v_readfirstlane_b32 s6, v5
    s_cmp_lg_u32 s6, 3
    s_cbranch_scc1 L_qnf_15
    v_readfirstlane_b32 s6, v10
    v_readfirstlane_b32 s7, v11
    v_mov_b32 v8, s71
    v_mov_b32 v11, s71
    v_mov_b32 v9, s6
    v_mov_b32 v10, s7
    v_lshlrev_b32 v5, 14, v0
    s_mov_b64 exec, 15
    s_cmp_eq_u32 s67, 0
    s_cbranch_scc1 L_sl_16
    buffer_store_dwordx4 v[8:11], v5, s[56:59], s49 offen
    s_branch L_sd_17
L_sl_16:
    buffer_store_dwordx4 v[8:11], v5, s[56:59], s49 offen sc1
L_sd_17:
    s_mov_b64 exec, -1
L_qnf_15:
    s_lshl_b32 s8, s4, 2
    s_and_b32 s6, s5, 3
    s_add_u32 s8, s8, s6
    s_lshr_b32 s9, s5, 2
    s_lshl_b32 s9, s9, 3
    s_add_u32 s9, s9, s3
    v_lshlrev_b32 v109, 4, v0
    v_and_b32 v3, 15, v0
    v_lshrrev_b32 v4, 5, v0
    v_lshlrev_b32 v4, 8, v4
    v_lshl_add_u32 v3, v3, 4, v4
    v_add_u32 v110, 65536, v3
    v_and_b32 v3, 7, v0
    v_lshlrev_b32 v3, 2, v3
    v_add_u32 v2, 155648, v3
    v_mov_b32 v48, 0
    v_mov_b32 v92, 0
    v_mov_b32 v49, 0
    v_mov_b32 v93, 0
    v_mov_b32 v50, 0
    v_mov_b32 v94, 0
    v_mov_b32 v51, 0
    v_mov_b32 v95, 0
    v_mov_b32 v52, 0
    v_mov_b32 v96, 0
    v_mov_b32 v53, 0
    v_mov_b32 v97, 0
    v_mov_b32 v54, 0
    v_mov_b32 v98, 0
    v_mov_b32 v55, 0
    v_mov_b32 v99, 0
    v_mov_b32 v56, 0
    v_mov_b32 v100, 0
    v_mov_b32 v57, 0
    v_mov_b32 v101, 0
    v_mov_b32 v58, 0
    v_mov_b32 v102, 0
    v_mov_b32 v59, 0
    v_mov_b32 v103, 0
    v_mov_b32 v60, 0
    v_mov_b32 v104, 0
    v_mov_b32 v61, 0
    v_mov_b32 v105, 0
    v_mov_b32 v62, 0
    v_mov_b32 v106, 0
    v_mov_b32 v63, 0
    v_mov_b32 v107, 0
    v_mov_b32 v40, 0
    v_mov_b32 v41, 0
    v_mov_b32 v42, 0
    v_mov_b32 v43, 0
    v_mov_b32 v44, 0
    v_mov_b32 v45, 0
    v_mov_b32 v46, 0
    v_mov_b32 v47, 0
    s_mov_b32 exec_lo, 0x110000
    s_mov_b32 exec_hi, 0x110000
    v_mov_b32 v92, 0x3f803f80
    v_mov_b32 v93, 0x3f803f80
    v_mov_b32 v94, 0x3f803f80
    v_mov_b32 v95, 0x3f803f80
    v_mov_b32 v96, 0x3f803f80
    v_mov_b32 v97, 0x3f803f80
    v_mov_b32 v98, 0x3f803f80
    v_mov_b32 v99, 0x3f803f80
    v_mov_b32 v100, 0x3f803f80
    v_mov_b32 v101, 0x3f803f80
    v_mov_b32 v102, 0x3f803f80
    v_mov_b32 v103, 0x3f803f80
    v_mov_b32 v104, 0x3f803f80
    v_mov_b32 v105, 0x3f803f80
    v_mov_b32 v106, 0x3f803f80
    v_mov_b32 v107, 0x3f803f80
    s_mov_b64 exec, -1
    s_nop 0
    v_mov_b32 v108, 0xdddddddd
    s_add_u32 s40, s38, 0x10000
    s_addc_u32 s41, s39, 0
    s_mov_b32 s42, 0x630000
    s_mov_b32 s43, 0x20000
    s_add_u32 s44, s38, 0xa60000
    s_addc_u32 s45, s39, 0
    s_mov_b32 s46, 0x200000
    s_mov_b32 s47, 0x20000
    s_and_b32 s11, s3, 3
    s_lshl_b32 s11, s11, 10
    s_lshl_b32 s54, s8, 16
    s_add_u32 s54, s54, 0x210000
    s_add_u32 s55, s54, 0x210000
    s_mov_b32 s64, 0
    s_lshl_b32 s64, s64, 13
    s_add_u32 s64, s64, s11
    s_add_u32 s64, s64, 12288
    s_and_b32 s64, s64, 0xffff
    s_lshl_b32 s15, s3, 2
    s_add_u32 s15, s15, 155648
    v_mov_b32 v111, s15
    s_setprio 2
    s_lshl_b32 s48, s8, 16
    s_lshl_b32 s7, s9, 10
    s_add_u32 s48, s48, s7
    s_mov_b32 s16, s20
    s_mov_b32 s17, s21
    s_mov_b32 s18, 0x80000
    s_mov_b32 s19, 0x20000
    v_lshrrev_b32 v7, 3, v0
    v_lshlrev_b32 v112, 10, v7
    v_bfe_u32 v7, v0, 4, 1
    v_lshlrev_b32 v7, 2, v7
    v_and_b32 v8, 7, v0
    v_xor_b32_e64 v7, v7, v8
    v_lshl_add_u32 v112, v7, 4, v112
    s_lshl_b32 s6, s3, 16
    s_and_b32 s7, s5, 7
    s_lshl_b32 s7, s7, 7
    s_add_u32 s61, s6, s7
    s_movk_i32 s60, 4
    v_mov_b32 v3, 1
    ds_write_b32 v111, v3
    v_mov_b32 v9, 155700
L_w_18:
    ds_read_b32 v8, v9
    s_waitcnt lgkmcnt(0)
    v_cmp_le_u32 vcc, 1, v8
    s_cmp_eq_u64 vcc, -1
    s_cbranch_scc1 L_wd_19
    s_sleep 1
    s_sub_u32 s70, s70, 1
    s_cmp_gt_i32 s70, 0
    s_cbranch_scc1 L_w_18
L_wd_19:
    s_add_u32 m0, s11, 12288
    s_add_u32 s6, s54, s64
    buffer_load_dwordx4 v109, s[40:43], s6 offen sc1 lds
    s_add_u32 m0, s11, 77824
    s_add_u32 s6, s55, s64
    buffer_load_dwordx4 v109, s[40:43], s6 offen sc1 lds
    s_add_u32 s64, s64, 4096
    s_and_b32 s64, s64, 0xffff
    s_add_u32 m0, s11, 16384
    s_add_u32 s6, s54, s64
    buffer_load_dwordx4 v109, s[40:43], s6 offen sc1 lds
    s_add_u32 m0, s11, 81920
    s_add_u32 s6, s55, s64
    buffer_load_dwordx4 v109, s[40:43], s6 offen sc1 lds
    s_add_u32 s64, s64, 4096
    s_and_b32 s64, s64, 0xffff
    s_add_u32 m0, s11, 20480
    s_add_u32 s6, s54, s64
    buffer_load_dwordx4 v109, s[40:43], s6 offen sc1 lds
    s_add_u32 m0, s11, 86016
    s_add_u32 s6, s55, s64
    buffer_load_dwordx4 v109, s[40:43], s6 offen sc1 lds
    s_add_u32 s64, s64, 4096
    s_and_b32 s64, s64, 0xffff
    s_add_u32 m0, s11, 24576
    s_add_u32 s6, s54, s64
    buffer_load_dwordx4 v109, s[40:43], s6 offen sc1 lds
    s_add_u32 m0, s11, 90112
    s_add_u32 s6, s55, s64
    buffer_load_dwordx4 v109, s[40:43], s6 offen sc1 lds
    s_add_u32 s64, s64, 4096
    s_and_b32 s64, s64, 0xffff
    buffer_load_dwordx4 v[80:83], v109, s[40:43], s48 offen sc1
    s_add_u32 m0, s11, 28672
    s_add_u32 s6, s54, s64
    buffer_load_dwordx4 v109, s[40:43], s6 offen sc1 lds
    s_add_u32 m0, s11, 94208
    s_add_u32 s6, s55, s64
    buffer_load_dwordx4 v109, s[40:43], s6 offen sc1 lds
    s_add_u32 s64, s64, 4096
    s_and_b32 s64, s64, 0xffff
    s_add_u32 m0, s11, 32768
    s_add_u32 s6, s54, s64
    buffer_load_dwordx4 v109, s[40:43], s6 offen sc1 lds
    s_add_u32 m0, s11, 98304
    s_add_u32 s6, s55, s64
    buffer_load_dwordx4 v109, s[40:43], s6 offen sc1 lds
    s_add_u32 s64, s64, 4096
    s_and_b32 s64, s64, 0xffff
    s_add_u32 m0, s11, 36864
    s_add_u32 s6, s54, s64
    buffer_load_dwordx4 v109, s[40:43], s6 offen sc1 lds
    s_add_u32 m0, s11, 102400
    s_add_u32 s6, s55, s64
    buffer_load_dwordx4 v109, s[40:43], s6 offen sc1 lds
    s_add_u32 s64, s64, 4096
    s_and_b32 s64, s64, 0xffff
    s_add_u32 m0, s11, 40960
    s_add_u32 s6, s54, s64
    buffer_load_dwordx4 v109, s[40:43], s6 offen sc1 lds
    s_add_u32 m0, s11, 106496
    s_add_u32 s6, s55, s64
    buffer_load_dwordx4 v109, s[40:43], s6 offen sc1 lds
    s_add_u32 s64, s64, 4096
    s_and_b32 s64, s64, 0xffff
    s_add_u32 m0, s11, 45056
    s_add_u32 s6, s54, s64
    buffer_load_dwordx4 v109, s[40:43], s6 offen sc1 lds
    s_add_u32 m0, s11, 110592
    s_add_u32 s6, s55, s64
    buffer_load_dwordx4 v109, s[40:43], s6 offen sc1 lds
    s_add_u32 s64, s64, 4096
    s_and_b32 s64, s64, 0xffff
    s_add_u32 m0, s11, 49152
    s_add_u32 s6, s54, s64
    buffer_load_dwordx4 v109, s[40:43], s6 offen sc1 lds
    s_add_u32 m0, s11, 114688
    s_add_u32 s6, s55, s64
    buffer_load_dwordx4 v109, s[40:43], s6 offen sc1 lds
    s_add_u32 s64, s64, 4096
    s_and_b32 s64, s64, 0xffff
    s_add_u32 m0, s11, 53248
    s_add_u32 s6, s54, s64
    buffer_load_dwordx4 v109, s[40:43], s6 offen sc1 lds
    s_add_u32 m0, s11, 118784
    s_add_u32 s6, s55, s64
    buffer_load_dwordx4 v109, s[40:43], s6 offen sc1 lds
    s_add_u32 s64, s64, 4096
    s_and_b32 s64, s64, 0xffff
    s_add_u32 m0, s11, 57344
    s_add_u32 s6, s54, s64
    buffer_load_dwordx4 v109, s[40:43], s6 offen sc1 lds
    s_add_u32 m0, s11, 122880
    s_add_u32 s6, s55, s64
    buffer_load_dwordx4 v109, s[40:43], s6 offen sc1 lds
    s_add_u32 s64, s64, 4096
    s_and_b32 s64, s64, 0xffff
    s_add_u32 m0, s11, 61440
    s_add_u32 s6, s54, s64
    buffer_load_dwordx4 v109, s[40:43], s6 offen sc1 lds
    s_add_u32 m0, s11, 126976
    s_add_u32 s6, s55, s64
    buffer_load_dwordx4 v109, s[40:43], s6 offen sc1 lds
    s_add_u32 s64, s64, 4096
    s_and_b32 s64, s64, 0xffff
    v_mov_b32 v3, 2
    s_waitcnt vmcnt(19)
    ds_write_b32 v111, v3
    v_mov_b32_e64 v4, 3
    s_waitcnt vmcnt(0)
    ds_write_b32 v111, v4
    s_mov_b32 s63, 0
L_attn:
    s_mov_b32 s12, 0xffff
    s_mov_b32 s13, 0xffff
    v_mov_b32 v9, 155744
L_w_22:
    ds_read_b32 v3, v2
    s_waitcnt lgkmcnt(0)
    v_cmp_le_u32 vcc, 1, v3
    s_cmp_eq_u64 vcc, -1
    s_cbranch_scc1 L_wd_23
    s_sleep 1
    s_sub_u32 s70, s70, 1
    s_cmp_gt_i32 s70, 0
    s_cbranch_scc1 L_w_22
L_wd_23:
    ds_read_b32 v8, v9
    ds_read_b128 v[84:87], v109
    ds_read_b128 v[88:91], v109 offset:1024
    s_mov_b64 exec, s[12:13]
    ds_read_b128 v[92:95], v110
    ds_read_b128 v[96:99], v110 offset:512
    s_mov_b64 exec, -1
    s_waitcnt lgkmcnt(4)
    v_readfirstlane_b32 s62, v8
    s_cmp_eq_u32 s62, 1
    s_cbranch_scc0 L_slow_20
    s_mov_b32 s14, 0
    s_movk_i32 s15, 0xa
    s_movk_i32 s11, 0x7fff
    s_movk_i32 s10, 0x7fff
    s_setprio 1
    s_cmp_eq_u32 s63, 0
    s_cbranch_scc1 L_np_24
    s_setprio 2
    s_movk_i32 s11, 6
L_np_24:
    s_waitcnt lgkmcnt(0)
    v_mfma_f32_32x32x16_bf16 v[16:31], v[84:87], v[80:83], 0
    s_nop 11
.p2align 6
L_att_25:
    s_bitcmp1_b32 s15, s14
    s_cbranch_scc1 L_chk_26
L_ret_27:
    s_cmp_eq_u32 s14, s11
    s_cbranch_scc1 L_sw_28
L_ret2_29:
    s_sub_u32 s6, s14, s60
    s_cmp_lt_u32 s6, 2
    s_cbranch_scc1 L_wo_30
L_ret3_31:
    v_exp_f32 v16, v16
    v_exp_f32_e64 v17, v17
    v_smfmac_f32_32x32x32_bf16 v[48:63], v[104:107], v[40:47], v108
    s_mov_b64 exec, s[12:13]
    ds_read_b128 v[100:103], v110 offset:1024
    ds_read_b128 v[104:107], v110 offset:1536
    s_mov_b64 exec, -1
    v_exp_f32 v18, v18
    v_exp_f32 v19, v19
    v_exp_f32 v20, v20
    s_waitcnt lgkmcnt(2)
    v_mfma_f32_32x32x16_bf16 v[32:47], v[88:91], v[80:83], 0
    ds_read_b128 v[84:87], v109 offset:2048
    v_exp_f32 v21, v21
    v_exp_f32 v22, v22
    v_exp_f32 v23, v23
    v_exp_f32 v24, v24
    v_exp_f32 v25, v25
    v_exp_f32 v26, v26
    v_smfmac_f32_32x32x32_bf16 v[48:63], v[92:95], v[16:23], v108
    v_exp_f32 v27, v27
    v_exp_f32 v28, v28
    v_exp_f32 v29, v29
    v_exp_f32 v30, v30
    v_exp_f32 v31, v31
    v_exp_f32 v32, v32
    v_exp_f32_e64 v33, v33
    v_smfmac_f32_32x32x32_bf16 v[48:63], v[96:99], v[24:31], v108
    s_mov_b64 exec, s[12:13]
    ds_read_b128 v[92:95], v110 offset:2048
    ds_read_b128 v[96:99], v110 offset:2560
    s_mov_b64 exec, -1
    v_exp_f32 v34, v34
    v_exp_f32 v35, v35
    v_exp_f32 v36, v36
    s_waitcnt lgkmcnt(2)
    v_mfma_f32_32x32x16_bf16 v[16:31], v[84:87], v[80:83], 0
    ds_read_b128 v[88:91], v109 offset:3072
    v_exp_f32 v37, v37
    v_exp_f32 v38, v38
    v_exp_f32 v39, v39
    v_exp_f32 v40, v40
    v_exp_f32 v41, v41
    v_exp_f32 v42, v42
    v_smfmac_f32_32x32x32_bf16 v[48:63], v[100:103], v[32:39], v108
    v_exp_f32 v43, v43
    v_exp_f32 v44, v44
    v_exp_f32 v45, v45
    v_exp_f32 v46, v46
    v_exp_f32 v47, v47
    v_exp_f32 v16, v16
    v_exp_f32_e64 v17, v17
    v_smfmac_f32_32x32x32_bf16 v[48:63], v[104:107], v[40:47], v108
    s_mov_b64 exec, s[12:13]
    ds_read_b128 v[100:103], v110 offset:3072
    ds_read_b128 v[104:107], v110 offset:3584
    s_mov_b64 exec, -1
    v_exp_f32 v18, v18
    v_exp_f32 v19, v19
    v_exp_f32 v20, v20
    s_waitcnt lgkmcnt(2)
    v_mfma_f32_32x32x16_bf16 v[32:47], v[88:91], v[80:83], 0
    ds_read_b128 v[84:87], v109 offset:4096
    v_exp_f32 v21, v21
    v_exp_f32 v22, v22
    v_exp_f32 v23, v23
    v_exp_f32 v24, v24
    v_exp_f32 v25, v25
    v_exp_f32 v26, v26
    v_smfmac_f32_32x32x32_bf16 v[48:63], v[92:95], v[16:23], v108
    v_exp_f32 v27, v27
    v_exp_f32 v28, v28
    v_exp_f32 v29, v29
    v_exp_f32 v30, v30
    v_exp_f32 v31, v31
    v_exp_f32 v32, v32
    v_exp_f32_e64 v33, v33
    v_smfmac_f32_32x32x32_bf16 v[48:63], v[96:99], v[24:31], v108
    s_mov_b64 exec, s[12:13]
    ds_read_b128 v[92:95], v110 offset:4096
    ds_read_b128 v[96:99], v110 offset:4608
    s_mov_b64 exec, -1
    v_exp_f32 v34, v34
    v_exp_f32 v35, v35
    v_exp_f32 v36, v36
    s_waitcnt lgkmcnt(2)
    v_mfma_f32_32x32x16_bf16 v[16:31], v[84:87], v[80:83], 0
    ds_read_b128 v[88:91], v109 offset:5120
    v_exp_f32 v37, v37
    v_exp_f32 v38, v38
    v_exp_f32 v39, v39
    v_exp_f32 v40, v40
    v_exp_f32 v41, v41
    v_exp_f32 v42, v42
    v_smfmac_f32_32x32x32_bf16 v[48:63], v[100:103], v[32:39], v108
    v_exp_f32 v43, v43
    v_exp_f32 v44, v44
    v_exp_f32 v45, v45
    v_exp_f32 v46, v46
    v_exp_f32 v47, v47
    v_exp_f32 v16, v16
    v_exp_f32_e64 v17, v17
    v_smfmac_f32_32x32x32_bf16 v[48:63], v[104:107], v[40:47], v108
    s_mov_b64 exec, s[12:13]
    ds_read_b128 v[100:103], v110 offset:5120
    ds_read_b128 v[104:107], v110 offset:5632
    s_mov_b64 exec, -1
    v_exp_f32 v18, v18
    v_exp_f32 v19, v19
    v_exp_f32 v20, v20
    s_waitcnt lgkmcnt(2)
    v_mfma_f32_32x32x16_bf16 v[32:47], v[88:91], v[80:83], 0
    ds_read_b128 v[84:87], v109 offset:6144
    v_exp_f32 v21, v21
    v_exp_f32 v22, v22
    v_exp_f32 v23, v23
    v_exp_f32 v24, v24
    v_exp_f32 v25, v25
    v_exp_f32 v26, v26
    v_smfmac_f32_32x32x32_bf16 v[48:63], v[92:95], v[16:23], v108
    v_exp_f32 v27, v27
    v_exp_f32 v28, v28
    v_exp_f32 v29, v29
    v_exp_f32 v30, v30
    v_exp_f32 v31, v31
    v_exp_f32 v32, v32
    v_exp_f32_e64 v33, v33
    v_smfmac_f32_32x32x32_bf16 v[48:63], v[96:99], v[24:31], v108
    s_mov_b64 exec, s[12:13]
    ds_read_b128 v[92:95], v110 offset:6144
    ds_read_b128 v[96:99], v110 offset:6656
    s_mov_b64 exec, -1
    v_exp_f32 v34, v34
    v_exp_f32 v35, v35
    v_exp_f32 v36, v36
    s_waitcnt lgkmcnt(2)
    v_mfma_f32_32x32x16_bf16 v[16:31], v[84:87], v[80:83], 0
    ds_read_b128 v[88:91], v109 offset:7168
    v_exp_f32 v37, v37
    v_exp_f32 v38, v38
    v_exp_f32 v39, v39
    v_exp_f32 v40, v40
    v_exp_f32 v41, v41
    v_exp_f32 v42, v42
    v_smfmac_f32_32x32x32_bf16 v[48:63], v[100:103], v[32:39], v108
    v_exp_f32 v43, v43
    v_exp_f32 v44, v44
    v_exp_f32 v45, v45
    v_exp_f32 v46, v46
    v_exp_f32 v47, v47
    v_exp_f32 v16, v16
    v_exp_f32_e64 v17, v17
    v_smfmac_f32_32x32x32_bf16 v[48:63], v[104:107], v[40:47], v108
    s_mov_b64 exec, s[12:13]
    ds_read_b128 v[100:103], v110 offset:7168
    ds_read_b128 v[104:107], v110 offset:7680
    s_mov_b64 exec, -1
    v_exp_f32 v18, v18
    v_exp_f32 v19, v19
    v_exp_f32 v20, v20
    s_waitcnt lgkmcnt(2)
    v_mfma_f32_32x32x16_bf16 v[32:47], v[88:91], v[80:83], 0
    ds_read_b128 v[84:87], v109 offset:8192
    v_exp_f32 v21, v21
    v_exp_f32 v22, v22
    v_exp_f32 v23, v23
    v_exp_f32 v24, v24
    v_exp_f32 v25, v25
    v_exp_f32 v26, v26
    v_smfmac_f32_32x32x32_bf16 v[48:63], v[92:95], v[16:23], v108
    v_exp_f32 v27, v27
    v_exp_f32 v28, v28
    v_exp_f32 v29, v29
    v_exp_f32 v30, v30
    v_exp_f32 v31, v31
    v_exp_f32 v32, v32
    v_exp_f32_e64 v33, v33
    v_smfmac_f32_32x32x32_bf16 v[48:63], v[96:99], v[24:31], v108
    s_mov_b64 exec, s[12:13]
    ds_read_b128 v[92:95], v110 offset:8192
    ds_read_b128 v[96:99], v110 offset:8704
    s_mov_b64 exec, -1
    v_exp_f32 v34, v34
    v_exp_f32 v35, v35
    v_exp_f32 v36, v36
    s_waitcnt lgkmcnt(2)
    v_mfma_f32_32x32x16_bf16 v[16:31], v[84:87], v[80:83], 0
    ds_read_b128 v[88:91], v109 offset:9216
    v_exp_f32 v37, v37
    v_exp_f32 v38, v38
    v_exp_f32 v39, v39
    v_exp_f32 v40, v40
    v_exp_f32 v41, v41
    v_exp_f32 v42, v42
    v_smfmac_f32_32x32x32_bf16 v[48:63], v[100:103], v[32:39], v108
    v_exp_f32 v43, v43
    v_exp_f32 v44, v44
    v_exp_f32 v45, v45
    v_exp_f32 v46, v46
    v_exp_f32_e64 v47, v47
    v_add_u32 v109, 8192, v109
    v_add_u32 v110, 8192, v110
    s_add_u32 s14, s14, 1
    s_cmp_lt_u32 s14, 8
    s_cbranch_scc1 L_att_25
    s_branch L_attepi_21
L_chk_26:
    s_lshr_b32 s6, s14, 1
    s_add_u32 s6, s6, 2
L_w_32:
    ds_read_b32 v3, v2
    s_waitcnt lgkmcnt(0)
    v_cmp_le_u32 vcc, s6, v3
    s_cmp_eq_u64 vcc, -1
    s_cbranch_scc1 L_wd_33
    s_sleep 1
    s_sub_u32 s70, s70, 1
    s_cmp_gt_i32 s70, 0
    s_cbranch_scc1 L_w_32
L_wd_33:
    s_branch L_ret_27
L_sw_28:
    s_setprio 0
    s_branch L_ret2_29
L_wo_30:
    s_cmp_lg_u32 s6, 0
    s_cbranch_scc1 L_wk_34
    buffer_load_dwordx4 v[120:123], v112, s[16:19], s61 offen
    s_add_u32 s61, s61, 8192
    buffer_load_dwordx4 v[124:127], v112, s[16:19], s61 offen
    s_add_u32 s61, s61, 8192
    buffer_load_dwordx4 v[128:131], v112, s[16:19], s61 offen
    s_add_u32 s61, s61, 8192
    buffer_load_dwordx4 v[132:135], v112, s[16:19], s61 offen
    s_add_u32 s61, s61, 8192
    s_branch L_ret3_31
L_wk_34:
    buffer_load_dwordx4 v[136:139], v112, s[16:19], s61 offen
    s_add_u32 s61, s61, 8192
    buffer_load_dwordx4 v[140:143], v112, s[16:19], s61 offen
    s_add_u32 s61, s61, 8192
    buffer_load_dwordx4 v[144:147], v112, s[16:19], s61 offen
    s_add_u32 s61, s61, 8192
    buffer_load_dwordx4 v[148:151], v112, s[16:19], s61 offen
    s_add_u32 s61, s61, 8192
    s_branch L_ret3_31
L_wk_35:
L_slow_20:
L_w_36:
    ds_read_b32 v3, v2
    s_waitcnt lgkmcnt(0)
    v_cmp_le_u32 vcc, 3, v3
    s_cmp_eq_u64 vcc, -1
    s_cbranch_scc1 L_wd_37
    s_sleep 1
    s_sub_u32 s70, s70, 1
    s_cmp_gt_i32 s70, 0
    s_cbranch_scc1 L_w_36
L_wd_37:
    s_nop 0
    v_mov_b32 v9, 0xff800000
    v_mov_b32 v10, v109
    s_mov_b32 s6, 64
L_fb_38:
    ds_read_b128 v[84:87], v10
    v_add_u32 v10, 1024, v10
    s_waitcnt lgkmcnt(0)
    s_nop 0
    v_mfma_f32_32x32x16_bf16 v[16:31], v[84:87], v[80:83], 0
    s_nop 15
    s_nop 0
    v_max3_f32 v9, v9, v16, v17
    v_max3_f32 v9, v9, v18, v19
    v_max3_f32 v9, v9, v20, v21
    v_max3_f32 v9, v9, v22, v23
    v_max3_f32 v9, v9, v24, v25
    v_max3_f32 v9, v9, v26, v27
    v_max3_f32 v9, v9, v28, v29
    v_max3_f32 v9, v9, v30, v31
    s_sub_u32 s6, s6, 1
    s_cmp_lg_u32 s6, 0
    s_cbranch_scc1 L_fb_38
    v_mov_b32 v10, v9
    s_nop 1
    v_permlane32_swap_b32 v9, v10
    v_max_f32 v9, v9, v10
    v_sub_f32 v64, 0, v9
    v_sub_f32 v65, 0, v9
    v_sub_f32 v66, 0, v9
    v_sub_f32 v67, 0, v9
    v_sub_f32 v68, 0, v9
    v_sub_f32 v69, 0, v9
    v_sub_f32 v70, 0, v9
    v_sub_f32 v71, 0, v9
    v_sub_f32 v72, 0, v9
    v_sub_f32 v73, 0, v9
    v_sub_f32 v74, 0, v9
    v_sub_f32 v75, 0, v9
    v_sub_f32 v76, 0, v9
    v_sub_f32 v77, 0, v9
    v_sub_f32 v78, 0, v9
    v_sub_f32_e64 v79, 0, v9
    ds_read_b128 v[84:87], v109
    ds_read_b128 v[88:91], v109 offset:1024
    s_mov_b64 exec, s[12:13]
    ds_read_b128 v[92:95], v110
    ds_read_b128 v[96:99], v110 offset:512
    s_mov_b64 exec, -1
    s_mov_b32 s14, 0
    s_movk_i32 s15, 0xa
    s_movk_i32 s11, 0x7fff
    s_movk_i32 s10, 0x7fff
    s_setprio 1
    s_cmp_eq_u32 s63, 0
    s_cbranch_scc1 L_np_39
    s_setprio 2
    s_movk_i32 s11, 6
L_np_39:
    s_waitcnt lgkmcnt(0)
    v_mfma_f32_32x32x16_bf16 v[16:31], v[84:87], v[80:83], v[64:79]
    s_nop 11
.p2align 6
L_att_40:
    s_bitcmp1_b32 s15, s14
    s_cbranch_scc1 L_chk_41
L_ret_42:
    s_cmp_eq_u32 s14, s11
    s_cbranch_scc1 L_sw_43
L_ret2_44:
    s_sub_u32 s6, s14, s60
    s_cmp_lt_u32 s6, 2
    s_cbranch_scc1 L_wo_45
L_ret3_46:
    v_exp_f32 v16, v16
    v_exp_f32_e64 v17, v17
    v_smfmac_f32_32x32x32_bf16 v[48:63], v[104:107], v[40:47], v108
    s_mov_b64 exec, s[12:13]
    ds_read_b128 v[100:103], v110 offset:1024
    ds_read_b128 v[104:107], v110 offset:1536
    s_mov_b64 exec, -1
    v_exp_f32 v18, v18
    v_exp_f32 v19, v19
    v_exp_f32 v20, v20
    s_waitcnt lgkmcnt(2)
    v_mfma_f32_32x32x16_bf16 v[32:47], v[88:91], v[80:83], v[64:79]
    ds_read_b128 v[84:87], v109 offset:2048
    v_exp_f32 v21, v21
    v_exp_f32 v22, v22
    v_exp_f32 v23, v23
    v_exp_f32 v24, v24
    v_exp_f32 v25, v25
    v_exp_f32 v26, v26
    v_smfmac_f32_32x32x32_bf16 v[48:63], v[92:95], v[16:23], v108
    v_exp_f32 v27, v27
    v_exp_f32 v28, v28
    v_exp_f32 v29, v29
    v_exp_f32 v30, v30
    v_exp_f32 v31, v31
    v_exp_f32 v32, v32
    v_exp_f32_e64 v33, v33
    v_smfmac_f32_32x32x32_bf16 v[48:63], v[96:99], v[24:31], v108
    s_mov_b64 exec, s[12:13]
    ds_read_b128 v[92:95], v110 offset:2048
    ds_read_b128 v[96:99], v110 offset:2560
    s_mov_b64 exec, -1
    v_exp_f32 v34, v34
    v_exp_f32 v35, v35
    v_exp_f32 v36, v36
    s_waitcnt lgkmcnt(2)
    v_mfma_f32_32x32x16_bf16 v[16:31], v[84:87], v[80:83], v[64:79]
    ds_read_b128 v[88:91], v109 offset:3072
    v_exp_f32 v37, v37
    v_exp_f32 v38, v38
    v_exp_f32 v39, v39
    v_exp_f32 v40, v40
    v_exp_f32 v41, v41
    v_exp_f32 v42, v42
    v_smfmac_f32_32x32x32_bf16 v[48:63], v[100:103], v[32:39], v108
    v_exp_f32 v43, v43
    v_exp_f32 v44, v44
    v_exp_f32 v45, v45
    v_exp_f32 v46, v46
    v_exp_f32 v47, v47
    v_exp_f32 v16, v16
    v_exp_f32_e64 v17, v17
    v_smfmac_f32_32x32x32_bf16 v[48:63], v[104:107], v[40:47], v108
    s_mov_b64 exec, s[12:13]
    ds_read_b128 v[100:103], v110 offset:3072
    ds_read_b128 v[104:107], v110 offset:3584
    s_mov_b64 exec, -1
    v_exp_f32 v18, v18
    v_exp_f32 v19, v19
    v_exp_f32 v20, v20
    s_waitcnt lgkmcnt(2)
    v_mfma_f32_32x32x16_bf16 v[32:47], v[88:91], v[80:83], v[64:79]
    ds_read_b128 v[84:87], v109 offset:4096
    v_exp_f32 v21, v21
    v_exp_f32 v22, v22
    v_exp_f32 v23, v23
    v_exp_f32 v24, v24
    v_exp_f32 v25, v25
    v_exp_f32 v26, v26
    v_smfmac_f32_32x32x32_bf16 v[48:63], v[92:95], v[16:23], v108
    v_exp_f32 v27, v27
    v_exp_f32 v28, v28
    v_exp_f32 v29, v29
    v_exp_f32 v30, v30
    v_exp_f32 v31, v31
    v_exp_f32 v32, v32
    v_exp_f32_e64 v33, v33
    v_smfmac_f32_32x32x32_bf16 v[48:63], v[96:99], v[24:31], v108
    s_mov_b64 exec, s[12:13]
    ds_read_b128 v[92:95], v110 offset:4096
    ds_read_b128 v[96:99], v110 offset:4608
    s_mov_b64 exec, -1
    v_exp_f32 v34, v34
    v_exp_f32 v35, v35
    v_exp_f32 v36, v36
    s_waitcnt lgkmcnt(2)
    v_mfma_f32_32x32x16_bf16 v[16:31], v[84:87], v[80:83], v[64:79]
    ds_read_b128 v[88:91], v109 offset:5120
    v_exp_f32 v37, v37
    v_exp_f32 v38, v38
    v_exp_f32 v39, v39
    v_exp_f32 v40, v40
    v_exp_f32 v41, v41
    v_exp_f32 v42, v42
    v_smfmac_f32_32x32x32_bf16 v[48:63], v[100:103], v[32:39], v108
    v_exp_f32 v43, v43
    v_exp_f32 v44, v44
    v_exp_f32 v45, v45
    v_exp_f32 v46, v46
    v_exp_f32 v47, v47
    v_exp_f32 v16, v16
    v_exp_f32_e64 v17, v17
    v_smfmac_f32_32x32x32_bf16 v[48:63], v[104:107], v[40:47], v108
    s_mov_b64 exec, s[12:13]
    ds_read_b128 v[100:103], v110 offset:5120
    ds_read_b128 v[104:107], v110 offset:5632
    s_mov_b64 exec, -1
    v_exp_f32 v18, v18
    v_exp_f32 v19, v19
    v_exp_f32 v20, v20
    s_waitcnt lgkmcnt(2)
    v_mfma_f32_32x32x16_bf16 v[32:47], v[88:91], v[80:83], v[64:79]
    ds_read_b128 v[84:87], v109 offset:6144
    v_exp_f32 v21, v21
    v_exp_f32 v22, v22
    v_exp_f32 v23, v23
    v_exp_f32 v24, v24
    v_exp_f32 v25, v25
    v_exp_f32 v26, v26
    v_smfmac_f32_32x32x32_bf16 v[48:63], v[92:95], v[16:23], v108
    v_exp_f32 v27, v27
    v_exp_f32 v28, v28
    v_exp_f32 v29, v29
    v_exp_f32 v30, v30
    v_exp_f32 v31, v31
    v_exp_f32 v32, v32
    v_exp_f32_e64 v33, v33
    v_smfmac_f32_32x32x32_bf16 v[48:63], v[96:99], v[24:31], v108
    s_mov_b64 exec, s[12:13]
    ds_read_b128 v[92:95], v110 offset:6144
    ds_read_b128 v[96:99], v110 offset:6656
    s_mov_b64 exec, -1
    v_exp_f32 v34, v34
    v_exp_f32 v35, v35
    v_exp_f32 v36, v36
    s_waitcnt lgkmcnt(2)
    v_mfma_f32_32x32x16_bf16 v[16:31], v[84:87], v[80:83], v[64:79]
    ds_read_b128 v[88:91], v109 offset:7168
    v_exp_f32 v37, v37
    v_exp_f32 v38, v38
    v_exp_f32 v39, v39
    v_exp_f32 v40, v40
    v_exp_f32 v41, v41
    v_exp_f32 v42, v42
    v_smfmac_f32_32x32x32_bf16 v[48:63], v[100:103], v[32:39], v108
    v_exp_f32 v43, v43
    v_exp_f32 v44, v44
    v_exp_f32 v45, v45
    v_exp_f32 v46, v46
    v_exp_f32 v47, v47
    v_exp_f32 v16, v16
    v_exp_f32_e64 v17, v17
    v_smfmac_f32_32x32x32_bf16 v[48:63], v[104:107], v[40:47], v108
    s_mov_b64 exec, s[12:13]
    ds_read_b128 v[100:103], v110 offset:7168
    ds_read_b128 v[104:107], v110 offset:7680
    s_mov_b64 exec, -1
    v_exp_f32 v18, v18
    v_exp_f32 v19, v19
    v_exp_f32 v20, v20
    s_waitcnt lgkmcnt(2)
    v_mfma_f32_32x32x16_bf16 v[32:47], v[88:91], v[80:83], v[64:79]
    ds_read_b128 v[84:87], v109 offset:8192
    v_exp_f32 v21, v21
    v_exp_f32 v22, v22
    v_exp_f32 v23, v23
    v_exp_f32 v24, v24
    v_exp_f32 v25, v25
    v_exp_f32 v26, v26
    v_smfmac_f32_32x32x32_bf16 v[48:63], v[92:95], v[16:23], v108
    v_exp_f32 v27, v27
    v_exp_f32 v28, v28
    v_exp_f32 v29, v29
    v_exp_f32 v30, v30
    v_exp_f32 v31, v31
    v_exp_f32 v32, v32
    v_exp_f32_e64 v33, v33
    v_smfmac_f32_32x32x32_bf16 v[48:63], v[96:99], v[24:31], v108
    s_mov_b64 exec, s[12:13]
    ds_read_b128 v[92:95], v110 offset:8192
    ds_read_b128 v[96:99], v110 offset:8704
    s_mov_b64 exec, -1
    v_exp_f32 v34, v34
    v_exp_f32 v35, v35
    v_exp_f32 v36, v36
    s_waitcnt lgkmcnt(2)
    v_mfma_f32_32x32x16_bf16 v[16:31], v[84:87], v[80:83], v[64:79]
    ds_read_b128 v[88:91], v109 offset:9216
    v_exp_f32 v37, v37
    v_exp_f32 v38, v38
    v_exp_f32 v39, v39
    v_exp_f32 v40, v40
    v_exp_f32 v41, v41
    v_exp_f32 v42, v42
    v_smfmac_f32_32x32x32_bf16 v[48:63], v[100:103], v[32:39], v108
    v_exp_f32 v43, v43
    v_exp_f32 v44, v44
    v_exp_f32 v45, v45
    v_exp_f32 v46, v46
    v_exp_f32_e64 v47, v47
    v_add_u32 v109, 8192, v109
    v_add_u32 v110, 8192, v110
    s_add_u32 s14, s14, 1
    s_cmp_lt_u32 s14, 8
    s_cbranch_scc1 L_att_40
    s_branch L_attepi_21
L_chk_41:
    s_lshr_b32 s6, s14, 1
    s_add_u32 s6, s6, 2
L_w_47:
    ds_read_b32 v3, v2
    s_waitcnt lgkmcnt(0)
    v_cmp_le_u32 vcc, s6, v3
    s_cmp_eq_u64 vcc, -1
    s_cbranch_scc1 L_wd_48
    s_sleep 1
    s_sub_u32 s70, s70, 1
    s_cmp_gt_i32 s70, 0
    s_cbranch_scc1 L_w_47
L_wd_48:
    s_branch L_ret_42
L_sw_43:
    s_setprio 0
    s_branch L_ret2_44
L_wo_45:
    s_cmp_lg_u32 s6, 0
    s_cbranch_scc1 L_wk_49
    buffer_load_dwordx4 v[120:123], v112, s[16:19], s61 offen
    s_add_u32 s61, s61, 8192
    buffer_load_dwordx4 v[124:127], v112, s[16:19], s61 offen
    s_add_u32 s61, s61, 8192
    buffer_load_dwordx4 v[128:131], v112, s[16:19], s61 offen
    s_add_u32 s61, s61, 8192
    buffer_load_dwordx4 v[132:135], v112, s[16:19], s61 offen
    s_add_u32 s61, s61, 8192
    s_branch L_ret3_46
L_wk_49:
    buffer_load_dwordx4 v[136:139], v112, s[16:19], s61 offen
    s_add_u32 s61, s61, 8192
    buffer_load_dwordx4 v[140:143], v112, s[16:19], s61 offen
    s_add_u32 s61, s61, 8192
    buffer_load_dwordx4 v[144:147], v112, s[16:19], s61 offen
    s_add_u32 s61, s61, 8192
    buffer_load_dwordx4 v[148:151], v112, s[16:19], s61 offen
    s_add_u32 s61, s61, 8192
    s_branch L_ret3_46
L_wk_50:
L_attepi_21:
    s_nop 0
    v_smfmac_f32_32x32x32_bf16 v[48:63], v[104:107], v[40:47], v108
    s_setprio 3
    s_lshl_b32 s6, s3, 2
    s_add_u32 s6, s6, 155712
    v_mov_b32 v4, s6
    v_mov_b32 v5, 1
    s_waitcnt lgkmcnt(0)
    ds_write_b32 v4, v5
    s_lshl_b32 s6, s9, 15
    s_lshl_b32 s7, s8, 10
    s_add_u32 s6, s6, s7
    v_lshlrev_b32 v3, 4, v0
    s_nop 4
    v_rcp_f32 v4, v56
    s_nop 0
    v_mul_f32 v48, v48, v4
    v_mul_f32 v49, v49, v4
    v_mul_f32 v50, v50, v4
    v_mul_f32 v51, v51, v4
    v_mul_f32 v52, v52, v4
    v_mul_f32 v53, v53, v4
    v_mul_f32 v54, v54, v4
    v_mul_f32 v55, v55, v4
    v_cvt_pk_bf16_f32 v8, v48, v49
    v_cvt_pk_bf16_f32 v9, v50, v51
    v_cvt_pk_bf16_f32 v10, v52, v53
    v_cvt_pk_bf16_f32 v11, v54, v55
    buffer_store_dwordx4 v[8:11], v3, s[44:47], s6 offen sc1
    s_lshr_b32 s6, s5, 2
    s_lshl_b32 s6, s6, 1
    s_lshr_b32 s7, s8, 4
    s_add_u32 s6, s6, s7
    s_lshl_b32 s6, s6, 7
    s_and_b32 s7, s8, 15
    s_lshl_b32 s7, s7, 2
    s_add_u32 s15, s6, s7
    s_add_u32 s15, s15, 4096
    s_waitcnt vmcnt(0)
    s_nop 0
    v_mov_b32 v4, 155704
    v_mov_b32 v5, 1
    s_mov_b64 exec, 1
    ds_add_rtn_u32 v5, v4, v5
    s_waitcnt lgkmcnt(0)
    s_mov_b64 exec, -1
    v_readfirstlane_b32 s6, v5
    s_cmp_lg_u32 s6, 7
    s_cbranch_scc1 L_nf_51
    v_mov_b32 v4, s71
    v_lshlrev_b32 v5, 14, v0
    s_mov_b64 exec, 255
    buffer_store_dword v4, v5, s[56:59], s15 offen sc1
    s_mov_b64 exec, -1
L_nf_51:
    s_setprio 0
    v_and_b32 v8, 7, v0
    v_lshlrev_b32_e64 v8, 2, v8
    v_add_u32 v8, 155712, v8
    s_lshl_b32 s11, s3, 13
    v_add_u32 v2, s11, v3
L_w_52:
    ds_read_b32 v7, v8
    s_waitcnt lgkmcnt(0)
    v_cmp_le_u32 vcc, 1, v7
    s_cmp_eq_u64 vcc, -1
    s_cbranch_scc1 L_wd_53
    s_sleep 1
    s_sub_u32 s70, s70, 1
    s_cmp_gt_i32 s70, 0
    s_cbranch_scc1 L_w_52
L_wd_53:
    ds_write_b128 v2, v[120:123] offset:0
    ds_write_b128 v2, v[124:127] offset:1024
    ds_write_b128 v2, v[128:131] offset:2048
    ds_write_b128 v2, v[132:135] offset:3072
    ds_write_b128 v2, v[136:139] offset:4096
    ds_write_b128 v2, v[140:143] offset:5120
    ds_write_b128 v2, v[144:147] offset:6144
    ds_write_b128 v2, v[148:151] offset:7168
    s_lshl_b32 s14, s4, 2
    s_lshr_b32 s6, s5, 3
    s_add_u32 s14, s14, s6
    s_lshl_b32 s14, s14, 16
    s_lshl_b32 s11, s3, 12
    s_add_u32 s14, s14, s11
    s_add_u32 s15, s14, 0x8000
    s_lshl_b32 s6, s3, 2
    s_add_u32 s6, s6, 155792
    v_mov_b32 v4, s6
    v_mov_b32_e64 v5, 1
    v_mov_b32 v9, 155708
    s_lshl_b32 s48, s3, 2
    s_cmp_lg_u32 s3, 0
    s_cbranch_scc1 L_ow_54
    s_lshl_b32 s7, s4, 8
    s_and_b32 s6, s5, 7
    s_lshl_b32 s6, s6, 14
    s_add_u32 s7, s7, s6
    s_add_u32 s7, s7, 4096
    v_lshlrev_b32 v7, 2, v0
    s_mov_b32 s49, 0
L_op_55:
    s_mov_b32 exec_lo, 0xffff
    s_mov_b32 exec_hi, 0xffff
    buffer_load_dword v8, v7, s[56:59], s7 offen sc1
    s_waitcnt vmcnt(0)
    v_cmp_eq_u32 vcc, s71, v8
    s_mov_b64 exec, -1
    s_lshl_b32 s6, vcc_hi, 16
    s_or_b32 s50, vcc_lo, s6
    s_lshr_b32 s6, s50, 1
    s_and_b32 s6, s6, s50
    s_lshr_b32 s51, s6, 2
    s_and_b32 s6, s6, s51
    s_cmp_gt_i32 s70, 0
    s_cselect_b32 s6, s6, -1
    s_cselect_b32 s50, s50, -1
    v_mov_b32 v8, s6
    ds_write_b32 v9, v8
    s_andn2_b32 s6, s6, s49
    s_bitcmp1_b32 s6, 0
    s_cbranch_scc0 L_oq_56
    s_mov_b32 s49, 1
    s_add_u32 m0, s11, 65536
    s_nop 0
    buffer_load_dwordx4 v3, s[44:47], s14 offen offset:0 sc1 lds
    s_add_u32 m0, s11, 65536
    s_nop 0
    buffer_load_dwordx4 v3, s[44:47], s14 offen offset:1024 sc1 lds
    s_add_u32 m0, s11, 65536
    s_nop 0
    buffer_load_dwordx4 v3, s[44:47], s14 offen offset:2048 sc1 lds
    s_add_u32 m0, s11, 65536
    s_nop 0
    buffer_load_dwordx4 v3, s[44:47], s14 offen offset:3072 sc1 lds
    s_add_u32 m0, s11, 98304
    s_nop 0
    buffer_load_dwordx4 v3, s[44:47], s15 offen offset:0 sc1 lds
    s_add_u32 m0, s11, 98304
    s_nop 0
    buffer_load_dwordx4 v3, s[44:47], s15 offen offset:1024 sc1 lds
    s_add_u32 m0, s11, 98304
    s_nop 0
    buffer_load_dwordx4 v3, s[44:47], s15 offen offset:2048 sc1 lds
    s_add_u32 m0, s11, 98304
    s_nop 0
    buffer_load_dwordx4 v3, s[44:47], s15 offen offset:3072 sc1 lds
L_oq_56:
    s_cmp_eq_u32 s50, -1
    s_cbranch_scc1 L_of_57
    s_sub_u32 s70, s70, 1
    s_sleep 1
    s_bcnt1_i32_b32 s6, s50
    s_cmp_ge_u32 s6, 24
    s_cbranch_scc1 L_op_55
    s_sleep 16
    s_branch L_op_55
L_ow_54:
    ds_read_b32 v8, v9
    s_waitcnt lgkmcnt(0)
    v_readfirstlane_b32 s6, v8
    s_bitcmp1_b32 s6, s48
    s_cbranch_scc1 L_og_58
    s_and_b32 s6, s6, 0x11111111
    s_bcnt1_i32_b32 s6, s6
    s_cmp_ge_u32 s6, 6
    s_cbranch_scc1 L_od_59
    s_sleep 2
    s_sub_u32 s70, s70, 1
    s_cmp_gt_i32 s70, 0
    s_cbranch_scc1 L_ow_54
L_od_59:
    s_lshl_b32 s7, s4, 8
    s_and_b32 s6, s5, 7
    s_lshl_b32 s6, s6, 14
    s_add_u32 s7, s7, s6
    s_lshr_b32 s6, s3, 2
    s_lshl_b32 s6, s6, 7
    s_add_u32 s7, s7, s6
    s_and_b32 s6, s3, 3
    s_lshl_b32 s6, s6, 4
    s_add_u32 s7, s7, s6
    s_add_u32 s7, s7, 4096
    v_lshlrev_b32 v7, 2, v0
    s_mov_b64 s[12:13], 15
    s_mov_b64 exec, s[12:13]
L_gp_60:
    buffer_load_dword v8, v7, s[56:59], s7 offen sc1
    s_waitcnt vmcnt(0)
    v_cmp_eq_u32 vcc, s71, v8
    s_cmp_eq_u64 vcc, s[12:13]
    s_cbranch_scc1 L_gpd_61
    s_sleep 0
    s_sub_u32 s70, s70, 1
    s_cmp_gt_i32 s70, 0
    s_cbranch_scc1 L_gp_60
L_gpd_61:
    s_mov_b64 exec, -1
L_og_58:
    s_add_u32 m0, s11, 65536
    s_nop 0
    buffer_load_dwordx4 v3, s[44:47], s14 offen offset:0 sc1 lds
    s_add_u32 m0, s11, 65536
    s_nop 0
    buffer_load_dwordx4 v3, s[44:47], s14 offen offset:1024 sc1 lds
    s_add_u32 m0, s11, 65536
    s_nop 0
    buffer_load_dwordx4 v3, s[44:47], s14 offen offset:2048 sc1 lds
    s_add_u32 m0, s11, 65536
    s_nop 0
    buffer_load_dwordx4 v3, s[44:47], s14 offen offset:3072 sc1 lds
    s_add_u32 m0, s11, 98304
    s_nop 0
    buffer_load_dwordx4 v3, s[44:47], s15 offen offset:0 sc1 lds
    s_add_u32 m0, s11, 98304
    s_nop 0
    buffer_load_dwordx4 v3, s[44:47], s15 offen offset:1024 sc1 lds
    s_add_u32 m0, s11, 98304
    s_nop 0
    buffer_load_dwordx4 v3, s[44:47], s15 offen offset:2048 sc1 lds
    s_add_u32 m0, s11, 98304
    s_nop 0
    buffer_load_dwordx4 v3, s[44:47], s15 offen offset:3072 sc1 lds
L_of_57:
    s_waitcnt vmcnt(0) lgkmcnt(0)
    ds_write_b32 v4, v5
    s_waitcnt lgkmcnt(0)
    s_endpgm
L_mix:
    s_setprio 3
    s_sub_u32 s10, s3, 8
    s_lshl_b32 s11, s5, 3
    s_add_u32 s11, s11, s4
    s_lshl_b32 s6, s11, 13
    s_lshl_b32 s7, s10, 11
    s_add_u32 s6, s6, s7
    v_lshlrev_b32 v19, 4, v0
    s_add_u32 s48, s16, s6
    s_addc_u32 s49, s17, 0
    s_movk_i32 s50, 2048
    s_mov_b32 s51, 0x20000
    s_mov_b32 s52, s32
    s_mov_b32 s53, s33
    s_mov_b32 s54, 0x400
    s_mov_b32 s55, 0x20000
    buffer_load_dwordx4 v[44:47], v19, s[48:51], 0 offen
    buffer_load_dwordx4 v[48:51], v19, s[48:51], 0 offen offset:1024
    buffer_load_dwordx4 v[52:55], v19, s[52:55], 0 offen
    v_lshlrev_b32_e64 v7, 2, v0
    v_add_u32 v7, 155648, v7
    v_mov_b32 v8, 0
    ds_write_b32 v7, v8
    s_getreg_b32 s64, hwreg(HW_REG_XCC_ID)
    s_and_b32 s64, s64, 15
    s_add_u32 s56, s38, 0xc80000
    s_addc_u32 s57, s39, 0
    s_mov_b32 s58, 0x20100
    s_mov_b32 s59, 0x20000
    s_cmp_lg_u32 s10, 0
    s_cbranch_scc1 L_nx_62
    s_waitcnt vmcnt(3)
    v_readfirstlane_b32 s71, v60
    s_lshl_b32 s6, s4, 7
    s_lshl_b32 s7, s5, 2
    s_add_u32 s65, s6, s7
    s_add_u32 s65, s65, 7168
    s_mul_i32 s71, s71, 1664525
    s_add_u32 s71, s71, 1013904223
    s_add_u32 s64, s64, s71
    v_mov_b32 v7, s64
    v_lshlrev_b32 v8, 14, v0
    s_mov_b64 exec, 15
    buffer_store_dword v7, v8, s[56:59], s65 offen sc1
    s_mov_b64 exec, -1
L_nx_62:
    s_mul_i32 s50, s10, 6144
    s_add_u32 s50, s50, 131072
    s_and_b32 s6, s10, 1
    s_lshl_b32 s6, s6, 10
    v_lshlrev_b32 v3, 4, v0
    v_add_u32 v3, s6, v3
    v_xor_b32 v6, 1024, v3
    s_lshl_b32 s6, s10, 2
    s_add_u32 s6, s6, 155680
    v_mov_b32 v12, s6
    v_and_b32 v13, 3, v0
    v_lshlrev_b32 v13, 2, v13
    v_add_u32 v13, 155680, v13
    s_add_u32 s44, s38, 0x640000
    s_addc_u32 s45, s39, 0
    s_mov_b32 s46, 0x200000
    s_mov_b32 s47, 0x20000
    s_add_u32 s60, s38, 0xc70000
    s_addc_u32 s61, s39, 0
    s_mov_b32 s62, 0x2000
    s_mov_b32 s63, 0x20000
    s_mul_i32 s6, s10, 2176
    s_add_u32 s6, s6, 114688
    v_add_u32_e64 v56, s6, v19
    v_bfe_u32 v57, v0, 2, 2
    s_movk_i32 s6, 1088
    v_mul_u32_u24 v57, s6, v57
    v_lshrrev_b32_e64 v7, 4, v0
    v_lshl_add_u32 v57, v7, 5, v57
    v_and_b32_e64 v8, 3, v0
    v_lshl_add_u32 v57, v8, 3, v57
    s_lshl_b32 s6, s10, 8
    s_add_u32 s6, s6, 114688
    v_add_u32 v57, s6, v57
    v_lshrrev_b32 v58, 5, v0
    v_lshlrev_b32 v58, 10, v58
    v_and_b32_e64 v8, 31, v0
    v_lshl_add_u32 v58, v8, 4, v58
    v_and_b32 v59, 1, v7
    v_lshlrev_b32 v59, 2, v59
    s_lshr_b32 s6, s11, 1
    s_lshl_b32 s6, s6, 14
    s_and_b32 s7, s11, 1
    s_lshl_b32 s7, s7, 9
    s_add_u32 s14, s6, s7
    s_lshl_b32 s7, s10, 12
    s_add_u32 s14, s14, s7
    s_lshl_b32 s15, s11, 5
    s_lshl_b32 s7, s10, 3
    s_add_u32 s15, s15, s7
    s_sub_u32 s11, s5, 4
    s_and_b32 s54, s4, 1
    s_lshl_b32 s54, s54, 2
    s_and_b32 s6, s11, 3
    s_add_u32 s54, s54, s6
    s_lshr_b32 s55, s4, 1
    s_mul_i32 s55, s55, 7
    s_lshr_b32 s6, s11, 2
    s_add_u32 s55, s55, s6
    v_lshrrev_b32 v7, 3, v0
    s_movk_i32 s6, 3584
    v_mul_u32_u24 v2, s6, v7
    v_bfe_u32 v7, v0, 4, 1
    v_lshlrev_b32 v7, 2, v7
    v_and_b32 v8, 7, v0
    v_xor_b32_e64 v7, v7, v8
    v_lshl_add_u32 v2, v7, 4, v2
    v_lshrrev_b32 v4, 5, v0
    v_lshlrev_b32 v4, 3, v4
    v_bfe_u32 v7, v0, 2, 2
    v_add_u32 v4, v4, v7
    v_lshlrev_b32 v4, 7, v4
    v_bfe_u32 v7, v0, 4, 1
    v_lshl_add_u32 v4, v7, 5, v4
    v_and_b32_e64 v7, 1, v0
    v_lshl_add_u32 v4, v7, 4, v4
    v_bfe_u32 v7, v0, 1, 1
    v_lshl_add_u32 v4, v7, 3, v4
    v_bfe_u32 v7, v0, 3, 1
    v_lshl_add_u32 v4, v7, 6, v4
    s_lshr_b32 s6, s10, 1
    s_lshl_b32 s6, s6, 6
    v_xor_b32 v4, s6, v4
    v_add_u32 v4, s50, v4
    v_xor_b32 v5, 64, v4
    s_mul_i32 s51, s10, 1835008
    s_lshl_b32 s6, s55, 7
    s_add_u32 s51, s51, s6
    s_add_u32 s52, s51, 28672
    s_lshl_b32 s53, s10, 19
    s_lshl_b32 s6, s54, 11
    s_add_u32 s53, s53, s6
    v_lshlrev_b32 v14, 4, v0
    v_add_u32 v14, s50, v14
    s_mov_b32 s40, s24
    s_mov_b32 s41, s25
    s_mov_b32 s42, 0x700000
    s_mov_b32 s43, 0x20000
    s_mov_b32 s16, s26
    s_mov_b32 s17, s27
    s_mov_b32 s18, 0xe00
    s_mov_b32 s19, 0x20000
    v_lshrrev_b32 v7, 5, v0
    v_lshlrev_b32 v7, 4, v7
    s_lshl_b32 s6, s55, 7
    s_lshr_b32 s7, s10, 1
    s_lshl_b32 s7, s7, 6
    s_add_u32 s6, s6, s7
    buffer_load_dwordx4 v[112:115], v7, s[16:19], s6 offen
    buffer_load_dwordx4 v[116:119], v7, s[16:19], s6 offen offset:32
    s_waitcnt lgkmcnt(0)
    s_barrier
    s_cmp_lg_u32 s10, 0
    s_cbranch_scc1 L_nx_63
    s_waitcnt vmcnt(3)
    s_branch L_nx_64
L_nx_63:
    s_waitcnt vmcnt(2)
L_nx_64:
    v_lshlrev_b32 v16, 16, v44
    v_and_b32 v17, 0xffff0000, v44
    v_lshlrev_b32_e64 v18, 16, v45
    v_and_b32 v19, 0xffff0000, v45
    v_lshlrev_b32_e64 v20, 16, v46
    v_and_b32 v21, 0xffff0000, v46
    v_lshlrev_b32_e64 v22, 16, v47
    v_and_b32 v23, 0xffff0000, v47
    v_lshlrev_b32_e64 v24, 16, v48
    v_and_b32 v25, 0xffff0000, v48
    v_lshlrev_b32_e64 v26, 16, v49
    v_and_b32 v27, 0xffff0000, v49
    v_lshlrev_b32_e64 v28, 16, v50
    v_and_b32 v29, 0xffff0000, v50
    v_lshlrev_b32_e64 v30, 16, v51
    v_and_b32 v31, 0xffff0000, v51
    v_lshlrev_b32_e64 v32, 16, v52
    v_and_b32 v33, 0xffff0000, v52
    v_lshlrev_b32_e64 v34, 16, v53
    v_and_b32 v35, 0xffff0000, v53
    v_lshlrev_b32_e64 v36, 16, v54
    v_and_b32 v37, 0xffff0000, v54
    v_lshlrev_b32_e64 v38, 16, v55
    v_and_b32 v39, 0xffff0000, v55
    v_add_f32 v40, v16, v17
    v_add_f32 v41, v24, v25
    v_mul_f32 v42, v16, v32
    v_mul_f32 v43, v24, v32
    v_add_f32 v40, v40, v18
    v_add_f32 v41, v41, v26
    v_add_f32 v40, v40, v19
    v_add_f32 v41, v41, v27
    v_add_f32 v40, v40, v20
    v_add_f32 v41, v41, v28
    v_add_f32 v40, v40, v21
    v_add_f32 v41, v41, v29
    v_add_f32 v40, v40, v22
    v_add_f32 v41, v41, v30
    v_add_f32 v40, v40, v23
    v_add_f32 v41, v41, v31
    v_fmac_f32 v42, v17, v33
    v_fmac_f32 v43, v25, v33
    v_fmac_f32 v42, v18, v34
    v_fmac_f32 v43, v26, v34
    v_fmac_f32 v42, v19, v35
    v_fmac_f32 v43, v27, v35
    v_fmac_f32 v42, v20, v36
    v_fmac_f32 v43, v28, v36
    v_fmac_f32 v42, v21, v37
    v_fmac_f32 v43, v29, v37
    v_fmac_f32 v42, v22, v38
    v_fmac_f32 v43, v30, v38
    v_fmac_f32_e64 v42, v23, v39
    v_fmac_f32 v43, v31, v39
    s_nop 1
    v_add_f32_dpp v40, v40, v40 quad_perm:[1,0,3,2] row_mask:0xf bank_mask:0xf
    v_add_f32_dpp v41, v41, v41 quad_perm:[1,0,3,2] row_mask:0xf bank_mask:0xf
    v_add_f32_dpp v42, v42, v42 quad_perm:[1,0,3,2] row_mask:0xf bank_mask:0xf
    v_add_f32_dpp v43, v43, v43 quad_perm:[1,0,3,2] row_mask:0xf bank_mask:0xf
    v_add_f32_dpp v40, v40, v40 quad_perm:[2,3,0,1] row_mask:0xf bank_mask:0xf
    v_add_f32_dpp v41, v41, v41 quad_perm:[2,3,0,1] row_mask:0xf bank_mask:0xf
    v_add_f32_dpp v42, v42, v42 quad_perm:[2,3,0,1] row_mask:0xf bank_mask:0xf
    v_add_f32_dpp v43, v43, v43 quad_perm:[2,3,0,1] row_mask:0xf bank_mask:0xf
    v_add_f32_dpp v40, v40, v40 row_half_mirror row_mask:0xf bank_mask:0xf
    v_add_f32_dpp v41, v41, v41 row_half_mirror row_mask:0xf bank_mask:0xf
    v_add_f32_dpp v42, v42, v42 row_half_mirror row_mask:0xf bank_mask:0xf
    v_add_f32_dpp v43, v43, v43 row_half_mirror row_mask:0xf bank_mask:0xf
    v_add_f32_dpp v40, v40, v40 row_mirror row_mask:0xf bank_mask:0xf
    v_add_f32_dpp v41, v41, v41 row_mirror row_mask:0xf bank_mask:0xf
    v_add_f32_dpp v42, v42, v42 row_mirror row_mask:0xf bank_mask:0xf
    v_add_f32_dpp v43, v43, v43 row_mirror row_mask:0xf bank_mask:0xf
    s_nop 1
    v_permlane16_swap_b32 v40, v41
    v_permlane16_swap_b32 v42, v43
    v_add_f32 v40, v40, v41
    v_add_f32 v42, v42, v43
    s_nop 1
    v_permlane32_swap_b32 v40, v42
    v_add_f32 v40, v40, v42
    v_mul_f32 v41, 0x3b000000, v40
    v_mul_f32 v42, 0xbfb8aa3b, v40
    v_exp_f32_e64 v42, v42
    v_readlane_b32 s12, v41, 0
    v_readlane_b32 s13, v41, 16
    v_add_f32 v42, 1.0, v42
    v_rcp_f32 v42, v42
    s_barrier
    v_subrev_f32 v16, s12, v16
    v_subrev_f32 v24, s13, v24
    v_subrev_f32 v17, s12, v17
    v_subrev_f32 v25, s13, v25
    v_subrev_f32 v18, s12, v18
    v_subrev_f32 v26, s13, v26
    v_subrev_f32 v19, s12, v19
    v_subrev_f32 v27, s13, v27
    v_subrev_f32 v20, s12, v20
    v_subrev_f32 v28, s13, v28
    v_subrev_f32 v21, s12, v21
    v_subrev_f32 v29, s13, v29
    v_subrev_f32 v22, s12, v22
    v_subrev_f32 v30, s13, v30
    v_subrev_f32 v23, s12, v23
    v_subrev_f32 v31, s13, v31
    s_mov_b32 exec_lo, 0
    s_mov_b32 exec_hi, 0x10001
    buffer_store_dword v42, v59, s[60:63], s15 offen sc1
    s_mov_b64 exec, -1
    v_mul_f32 v40, v16, v16
    v_mul_f32 v41, v24, v24
    v_fmac_f32 v40, v17, v17
    v_fmac_f32 v41, v25, v25
    v_fmac_f32 v40, v18, v18
    v_fmac_f32 v41, v26, v26
    v_fmac_f32 v40, v19, v19
    v_fmac_f32 v41, v27, v27
    v_fmac_f32 v40, v20, v20
    v_fmac_f32 v41, v28, v28
    v_fmac_f32 v40, v21, v21
    v_fmac_f32 v41, v29, v29
    v_fmac_f32 v40, v22, v22
    v_fmac_f32 v41, v30, v30
    v_fmac_f32 v40, v23, v23
    v_fmac_f32 v41, v31, v31
    s_nop 1
    v_add_f32_dpp v40, v40, v40 quad_perm:[1,0,3,2] row_mask:0xf bank_mask:0xf
    v_add_f32_dpp v41, v41, v41 quad_perm:[1,0,3,2] row_mask:0xf bank_mask:0xf
    s_nop 0
    s_nop 0
    v_add_f32_dpp v40, v40, v40 quad_perm:[2,3,0,1] row_mask:0xf bank_mask:0xf
    v_add_f32_dpp v41, v41, v41 quad_perm:[2,3,0,1] row_mask:0xf bank_mask:0xf
    s_nop 0
    s_nop 0
    v_add_f32_dpp v40, v40, v40 row_half_mirror row_mask:0xf bank_mask:0xf
    v_add_f32_dpp v41, v41, v41 row_half_mirror row_mask:0xf bank_mask:0xf
    s_nop 0
    s_nop 0
    v_add_f32_dpp v40, v40, v40 row_mirror row_mask:0xf bank_mask:0xf
    v_add_f32_dpp v41, v41, v41 row_mirror row_mask:0xf bank_mask:0xf
    s_nop 0
    s_nop 0
    v_permlane16_swap_b32 v40, v41
    v_add_f32 v40, v40, v41
    v_mov_b32 v41, v40
    s_nop 1
    v_permlane32_swap_b32 v40, v41
    v_add_f32 v40, v40, v41
    v_mov_b32 v41, 0x3727c5ac
    v_fmac_f32 v41, 0x3b000000, v40
    v_rsq_f32 v41, v41
    s_nop 1
    v_readlane_b32 s12, v41, 0
    v_readlane_b32 s13, v41, 16
    s_nop 1
    v_mul_f32 v16, s12, v16
    v_mul_f32 v24, s13, v24
    v_mul_f32 v17, s12, v17
    v_mul_f32 v25, s13, v25
    v_mul_f32 v18, s12, v18
    v_mul_f32 v26, s13, v26
    v_mul_f32 v19, s12, v19
    v_mul_f32 v27, s13, v27
    v_mul_f32 v20, s12, v20
    v_mul_f32 v28, s13, v28
    v_mul_f32 v21, s12, v21
    v_mul_f32 v29, s13, v29
    v_mul_f32 v22, s12, v22
    v_mul_f32 v30, s13, v30
    v_mul_f32 v23, s12, v23
    v_mul_f32_e64 v31, s13, v31
    v_cvt_pk_bf16_f32 v44, v16, v17
    v_cvt_pk_bf16_f32 v48, v24, v25
    v_cvt_pk_bf16_f32 v45, v18, v19
    v_cvt_pk_bf16_f32 v49, v26, v27
    v_cvt_pk_bf16_f32 v46, v20, v21
    v_cvt_pk_bf16_f32 v50, v28, v29
    v_cvt_pk_bf16_f32 v47, v22, v23
    v_cvt_pk_bf16_f32 v51, v30, v31
    ds_write_b128 v56, v[44:47]
    ds_write_b128 v56, v[48:51] offset:1088
    s_waitcnt lgkmcnt(0)
    s_barrier
    ds_read_b64_tr_b16 v[20:21], v57
    ds_read_b64_tr_b16 v[22:23], v57 offset:4352
    ds_read_b64_tr_b16 v[24:25], v57 offset:128
    ds_read_b64_tr_b16 v[26:27], v57 offset:4480
    s_waitcnt lgkmcnt(0)
    buffer_store_dwordx4 v[20:23], v58, s[44:47], s14 offen sc1
    buffer_store_dwordx4 v[24:27], v58, s[44:47], s14 offen offset:2048 sc1
    s_barrier
    s_cmp_lg_u32 s10, 0
    s_cbranch_scc1 L_nx_65
    v_and_b32_e64 v7, 31, v0
    v_lshlrev_b32 v7, 2, v7
    s_lshl_b32 s6, s4, 7
    s_and_b32 s7, s5, 3
    s_lshl_b32 s7, s7, 14
    s_add_u32 s6, s6, s7
    s_add_u32 s6, s6, 7168
    buffer_load_dword v63, v7, s[56:59], s6 offen sc1
L_nx_65:
    s_barrier
    s_barrier
    s_barrier
    s_cmp_lg_u32 s10, 0
    s_cbranch_scc1 L_nx_66
    s_waitcnt vmcnt(0)
    v_cmp_eq_u32 vcc, s64, v63
    s_cmp_eq_u64 vcc, -1
    s_cselect_b32 s6, 1, 0
    v_mov_b32 v7, 155760
    v_mov_b32 v8, s71
    v_mov_b32 v9, s6
    ds_write_b64 v7, v[8:9]
    s_waitcnt lgkmcnt(0)
L_nx_66:
    s_barrier
    v_mov_b32 v7, 155760
    ds_read_b32 v7, v7
    s_waitcnt lgkmcnt(0)
    v_readfirstlane_b32 s71, v7
    s_lshr_b32 s6, s5, 1
    s_lshl_b32 s6, s6, 7
    s_and_b32 s7, s5, 1
    s_lshl_b32 s7, s7, 3
    s_add_u32 s7, s7, s4
    s_lshl_b32 s7, s7, 2
    s_add_u32 s15, s6, s7
    s_add_u32 s15, s15, 2048
    s_waitcnt vmcnt(0)
    v_mov_b32 v7, 155768
    v_mov_b32 v8, 1
    s_mov_b64 exec, 1
    ds_add_rtn_u32 v8, v7, v8
    s_waitcnt lgkmcnt(0)
    s_mov_b64 exec, -1
    v_readfirstlane_b32 s6, v8
    s_cmp_lg_u32 s6, 3
    s_cbranch_scc1 L_nf_67
    v_mov_b32 v7, s71
    v_lshlrev_b32 v8, 14, v0
    s_mov_b64 exec, 255
    buffer_store_dword v7, v8, s[56:59], s15 offen sc1
    s_mov_b64 exec, -1
L_nf_67:
L_mj_68:
    s_setprio 3
    s_cmp_lt_u32 s5, 4
    s_cbranch_scc1 L_skip1_69
    v_lshlrev_b32 v16, 16, v112
    v_and_b32 v17, 0xffff0000, v112
    v_lshlrev_b32_e64 v18, 16, v113
    v_and_b32 v19, 0xffff0000, v113
    v_lshlrev_b32_e64 v20, 16, v114
    v_and_b32 v21, 0xffff0000, v114
    v_lshlrev_b32_e64 v22, 16, v115
    v_and_b32 v23, 0xffff0000, v115
    v_lshlrev_b32_e64 v24, 16, v116
    v_and_b32 v25, 0xffff0000, v116
    v_lshlrev_b32_e64 v26, 16, v117
    v_and_b32 v27, 0xffff0000, v117
    v_lshlrev_b32_e64 v28, 16, v118
    v_and_b32 v29, 0xffff0000, v118
    v_lshlrev_b32_e64 v30, 16, v119
    v_and_b32 v31, 0xffff0000, v119
    v_mov_b32 v9, 155696
L_w_71:
    ds_read_b32 v8, v9
    s_waitcnt lgkmcnt(0)
    v_cmp_le_u32 vcc, 4, v8
    s_cmp_eq_u64 vcc, -1
    s_cbranch_scc1 L_wd_72
    s_sleep 1
    s_sub_u32 s70, s70, 1
    s_cmp_gt_i32 s70, 0
    s_cbranch_scc1 L_w_71
L_wd_72:
    v_mov_b32 v9, 155748
    s_cmp_lg_u32 s10, 0
    s_cbranch_scc1 L_np_73
    v_lshrrev_b32 v7, 2, v0
    v_lshlrev_b32 v7, 7, v7
    v_and_b32_e64 v8, 3, v0
    v_lshl_add_u32 v7, v8, 4, v7
    s_lshl_b32 s7, s4, 14
    s_add_u32 s7, s7, 2048
    s_mov_b64 s[12:13], -1
    s_mov_b64 exec, s[12:13]
L_gp_75:
    buffer_load_dwordx4 v[80:83], v7, s[56:59], s7 offen sc1
    s_waitcnt vmcnt(0)
    v_xor_b32 v80, s71, v80
    v_xor_b32 v81, s71, v81
    v_xor_b32 v82, s71, v82
    v_xor_b32 v83, s71, v83
    v_or3_b32 v80, v80, v81, v82
    v_or_b32_e64 v80, v80, v83
    v_cmp_eq_u32 vcc, 0, v80
    s_cmp_eq_u64 vcc, s[12:13]
    s_cbranch_scc1 L_gpd_76
    s_sleep 2
    s_sub_u32 s70, s70, 1
    s_cmp_gt_i32 s70, 0
    s_cbranch_scc1 L_gp_75
L_gpd_76:
    s_mov_b64 exec, -1
    v_mov_b32 v8, 1
    ds_write_b32 v9, v8
    s_branch L_pg_74
L_np_73:
L_w_77:
    ds_read_b32 v8, v9
    s_waitcnt lgkmcnt(0)
    v_cmp_le_u32 vcc, 1, v8
    s_cmp_eq_u64 vcc, -1
    s_cbranch_scc1 L_wd_78
    s_sleep 1
    s_sub_u32 s70, s70, 1
    s_cmp_gt_i32 s70, 0
    s_cbranch_scc1 L_w_77
L_wd_78:
L_pg_74:
    v_mov_b32 v9, 155700
L_w_79:
    ds_read_b32 v8, v9
    s_waitcnt lgkmcnt(0)
    v_cmp_le_u32 vcc, 1, v8
    s_cmp_eq_u64 vcc, -1
    s_cbranch_scc1 L_wd_80
    s_sleep 1
    s_sub_u32 s70, s70, 1
    s_cmp_gt_i32 s70, 0
    s_cbranch_scc1 L_w_79
L_wd_80:
    s_add_u32 m0, s50, 0
    s_add_u32 s52, s51, 28672
    buffer_load_dwordx4 v2, s[40:43], s51 offen lds
    s_add_u32 m0, s50, 1024
    s_add_u32 s51, s51, 57344
    buffer_load_dwordx4 v2, s[40:43], s52 offen lds
    s_add_u32 m0, s50, 2048
    s_add_u32 s52, s51, 28672
    buffer_load_dwordx4 v2, s[40:43], s51 offen lds
    s_add_u32 m0, s50, 3072
    s_add_u32 s51, s51, 57344
    buffer_load_dwordx4 v2, s[40:43], s52 offen lds
    s_add_u32 m0, s50, 4096
    s_add_u32 s52, s51, 28672
    buffer_load_dwordx4 v2, s[40:43], s51 offen lds
    s_add_u32 m0, s50, 5120
    s_add_u32 s51, s51, 57344
    buffer_load_dwordx4 v2, s[40:43], s52 offen lds
    buffer_load_dwordx4 v[128:131], v3, s[44:47], s53 offen sc1
    buffer_load_dwordx4 v[132:135], v6, s[44:47], s53 offen sc1
    s_add_u32 s53, s53, 16384
    buffer_load_dwordx4 v[136:139], v3, s[44:47], s53 offen sc1
    buffer_load_dwordx4 v[140:143], v6, s[44:47], s53 offen sc1
    s_add_u32 s53, s53, 16384
    buffer_load_dwordx4 v[144:147], v3, s[44:47], s53 offen sc1
    buffer_load_dwordx4 v[148:151], v6, s[44:47], s53 offen sc1
    s_add_u32 s53, s53, 16384
    buffer_load_dwordx4 v[152:155], v3, s[44:47], s53 offen sc1
    buffer_load_dwordx4 v[156:159], v6, s[44:47], s53 offen sc1
    s_add_u32 s53, s53, 16384
    buffer_load_dwordx4 v[160:163], v3, s[44:47], s53 offen sc1
    buffer_load_dwordx4 v[164:167], v6, s[44:47], s53 offen sc1
    s_add_u32 s53, s53, 16384
    v_lshlrev_b32 v7, 4, v0
    v_add_u32 v8, s50, v7
    s_xor_b32 s6, s10, 1
    s_mul_i32 s6, s6, 6144
    s_add_u32 s6, s6, 131072
    v_add_u32 v9, s6, v7
    s_xor_b32 s6, s10, 2
    s_mul_i32 s6, s6, 6144
    s_add_u32 s6, s6, 133120
    v_add_u32 v10, s6, v7
    s_xor_b32 s6, s10, 3
    s_mul_i32 s6, s6, 6144
    s_add_u32 s6, s6, 135168
    v_add_u32 v11, s6, v7
    s_add_u32 s16, s38, 0x850000
    s_addc_u32 s17, s39, 0
    s_mov_b32 s18, 0x1c0000
    s_mov_b32 s19, 0x20000
    v_and_b32 v7, 31, v0
    v_and_b32 v15, 0x13, v7
    v_and_b32_e64 v1, 4, v7
    v_lshl_or_b32 v15, v1, 1, v15
    v_and_b32 v1, 8, v7
    v_lshrrev_b32 v1, 1, v1
    v_or_b32 v15, v15, v1
    v_lshrrev_b32 v7, 5, v0
    v_lshlrev_b32_e64 v7, 9, v7
    v_lshl_add_u32 v15, v15, 4, v7
    s_lshl_b32 s6, s55, 2
    s_and_b32 s7, s10, 2
    s_add_u32 s6, s6, s7
    s_lshl_b32 s6, s6, 14
    s_lshl_b32 s7, s54, 1
    s_and_b32 s11, s10, 1
    s_add_u32 s7, s7, s11
    s_lshl_b32 s7, s7, 10
    s_add_u32 s68, s6, s7
    s_add_u32 s69, s68, 16384
    s_lshl_b32 s6, s54, 8
    s_lshl_b32 s7, s55, 2
    s_add_u32 s15, s6, s7
    s_cmp_ge_u32 s55, 14
    s_cselect_b32 s6, 72, 0
    s_add_u32 s15, s15, s6
    s_mov_b32 s48, 0xbdd2d3e8
    s_mov_b32 s49, s48
    s_setprio 1
    s_waitcnt vmcnt(14)
    ds_read_b64_tr_b16 v[80:81], v4 offset:0
    ds_read_b64_tr_b16 v[82:83], v4 offset:512
    ds_read_b64_tr_b16 v[84:85], v5 offset:0
    ds_read_b64_tr_b16 v[86:87], v5 offset:512
    s_waitcnt lgkmcnt(0)
    s_add_u32 m0, s50, 0
    s_add_u32 s52, s51, 28672
    buffer_load_dwordx4 v2, s[40:43], s51 offen lds
    s_add_u32 m0, s50, 1024
    s_add_u32 s51, s51, 57344
    buffer_load_dwordx4 v2, s[40:43], s52 offen lds
    s_waitcnt vmcnt(10)
    v_mfma_f32_32x32x16_bf16 v[16:31], v[80:83], v[128:131], v[16:31]
    ds_read_b64_tr_b16 v[88:89], v4 offset:2048
    ds_read_b64_tr_b16 v[90:91], v4 offset:2560
    v_mfma_f32_32x32x16_bf16 v[32:47], v[80:83], v[132:135], 0
    ds_read_b64_tr_b16 v[92:93], v5 offset:2048
    ds_read_b64_tr_b16 v[94:95], v5 offset:2560
    v_mfma_f32_32x32x16_bf16 v[48:63], v[84:87], v[128:131], 0
    v_mfma_f32_32x32x16_bf16 v[64:79], v[84:87], v[132:135], 0
    s_waitcnt lgkmcnt(0)
    s_add_u32 m0, s50, 2048
    s_add_u32 s52, s51, 28672
    buffer_load_dwordx4 v2, s[40:43], s51 offen lds
    s_add_u32 m0, s50, 3072
    s_add_u32 s51, s51, 57344
    buffer_load_dwordx4 v2, s[40:43], s52 offen lds
    s_waitcnt vmcnt(10)
    v_mfma_f32_32x32x16_bf16 v[16:31], v[88:91], v[136:139], v[16:31]
    ds_read_b64_tr_b16 v[80:81], v4 offset:4096
    ds_read_b64_tr_b16 v[82:83], v4 offset:4608
    v_mfma_f32_32x32x16_bf16 v[32:47], v[88:91], v[140:143], v[32:47]
    ds_read_b64_tr_b16 v[84:85], v5 offset:4096
    ds_read_b64_tr_b16 v[86:87], v5 offset:4608
    v_mfma_f32_32x32x16_bf16 v[48:63], v[92:95], v[136:139], v[48:63]
    buffer_load_dwordx4 v[128:131], v3, s[44:47], s53 offen sc1
    v_mfma_f32_32x32x16_bf16 v[64:79], v[92:95], v[140:143], v[64:79]
    buffer_load_dwordx4 v[132:135], v6, s[44:47], s53 offen sc1
    s_add_u32 s53, s53, 16384
    s_waitcnt lgkmcnt(0)
    s_add_u32 m0, s50, 4096
    s_add_u32 s52, s51, 28672
    buffer_load_dwordx4 v2, s[40:43], s51 offen lds
    s_add_u32 m0, s50, 5120
    s_add_u32 s51, s51, 57344
    buffer_load_dwordx4 v2, s[40:43], s52 offen lds
    s_waitcnt vmcnt(6)
    v_mfma_f32_32x32x16_bf16 v[16:31], v[80:83], v[144:147], v[16:31]
    ds_read_b64_tr_b16 v[88:89], v4 offset:0
    ds_read_b64_tr_b16 v[90:91], v4 offset:512
    v_mfma_f32_32x32x16_bf16 v[32:47], v[80:83], v[148:151], v[32:47]
    ds_read_b64_tr_b16 v[92:93], v5 offset:0
    ds_read_b64_tr_b16 v[94:95], v5 offset:512
    v_mfma_f32_32x32x16_bf16 v[48:63], v[84:87], v[144:147], v[48:63]
    buffer_load_dwordx4 v[136:139], v3, s[44:47], s53 offen sc1
    v_mfma_f32_32x32x16_bf16 v[64:79], v[84:87], v[148:151], v[64:79]
    buffer_load_dwordx4 v[140:143], v6, s[44:47], s53 offen sc1
    s_add_u32 s53, s53, 16384
    s_waitcnt lgkmcnt(0)
    s_add_u32 m0, s50, 0
    s_add_u32 s52, s51, 28672
    buffer_load_dwordx4 v2, s[40:43], s51 offen lds
    s_add_u32 m0, s50, 1024
    s_add_u32 s51, s51, 57344
    buffer_load_dwordx4 v2, s[40:43], s52 offen lds
    s_waitcnt vmcnt(8)
    s_nop 0
    v_mfma_f32_32x32x16_bf16 v[16:31], v[88:91], v[152:155], v[16:31]
    ds_read_b64_tr_b16 v[80:81], v4 offset:2048
    ds_read_b64_tr_b16 v[82:83], v4 offset:2560
    v_mfma_f32_32x32x16_bf16 v[32:47], v[88:91], v[156:159], v[32:47]
    ds_read_b64_tr_b16 v[84:85], v5 offset:2048
    ds_read_b64_tr_b16 v[86:87], v5 offset:2560
    v_mfma_f32_32x32x16_bf16 v[48:63], v[92:95], v[152:155], v[48:63]
    buffer_load_dwordx4 v[144:147], v3, s[44:47], s53 offen sc1
    v_mfma_f32_32x32x16_bf16 v[64:79], v[92:95], v[156:159], v[64:79]
    buffer_load_dwordx4 v[148:151], v6, s[44:47], s53 offen sc1
    s_add_u32 s53, s53, 16384
    s_waitcnt lgkmcnt(0)
    s_add_u32 m0, s50, 2048
    s_add_u32 s52, s51, 28672
    buffer_load_dwordx4 v2, s[40:43], s51 offen lds
    s_add_u32 m0, s50, 3072
    s_add_u32 s51, s51, 57344
    buffer_load_dwordx4 v2, s[40:43], s52 offen lds
    s_waitcnt vmcnt(8)
    v_mfma_f32_32x32x16_bf16 v[16:31], v[80:83], v[160:163], v[16:31]
    ds_read_b64_tr_b16 v[88:89], v4 offset:4096
    ds_read_b64_tr_b16 v[90:91], v4 offset:4608
    v_mfma_f32_32x32x16_bf16 v[32:47], v[80:83], v[164:167], v[32:47]
    ds_read_b64_tr_b16 v[92:93], v5 offset:4096
    ds_read_b64_tr_b16 v[94:95], v5 offset:4608
    v_mfma_f32_32x32x16_bf16 v[48:63], v[84:87], v[160:163], v[48:63]
    buffer_load_dwordx4 v[152:155], v3, s[44:47], s53 offen sc1
    v_mfma_f32_32x32x16_bf16 v[64:79], v[84:87], v[164:167], v[64:79]
    buffer_load_dwordx4 v[156:159], v6, s[44:47], s53 offen sc1
    s_add_u32 s53, s53, 16384
    s_waitcnt lgkmcnt(0)
    s_add_u32 m0, s50, 4096
    s_add_u32 s52, s51, 28672
    buffer_load_dwordx4 v2, s[40:43], s51 offen lds
    s_add_u32 m0, s50, 5120
    s_add_u32 s51, s51, 57344
    buffer_load_dwordx4 v2, s[40:43], s52 offen lds
    s_waitcnt vmcnt(8)
    v_mfma_f32_32x32x16_bf16 v[16:31], v[88:91], v[128:131], v[16:31]
    ds_read_b64_tr_b16 v[80:81], v4 offset:0
    ds_read_b64_tr_b16 v[82:83], v4 offset:512
    v_mfma_f32_32x32x16_bf16 v[32:47], v[88:91], v[132:135], v[32:47]
    ds_read_b64_tr_b16 v[84:85], v5 offset:0
    ds_read_b64_tr_b16 v[86:87], v5 offset:512
    v_mfma_f32_32x32x16_bf16 v[48:63], v[92:95], v[128:131], v[48:63]
    buffer_load_dwordx4 v[160:163], v3, s[44:47], s53 offen sc1
    v_mfma_f32_32x32x16_bf16 v[64:79], v[92:95], v[132:135], v[64:79]
    buffer_load_dwordx4 v[164:167], v6, s[44:47], s53 offen sc1
    s_add_u32 s53, s53, 16384
    s_waitcnt lgkmcnt(0)
    s_add_u32 m0, s50, 0
    s_add_u32 s52, s51, 28672
    buffer_load_dwordx4 v2, s[40:43], s51 offen lds
    s_add_u32 m0, s50, 1024
    s_add_u32 s51, s51, 57344
    buffer_load_dwordx4 v2, s[40:43], s52 offen lds
    s_waitcnt vmcnt(8)
    s_nop 0
    v_mfma_f32_32x32x16_bf16 v[16:31], v[80:83], v[136:139], v[16:31]
    ds_read_b64_tr_b16 v[88:89], v4 offset:2048
    ds_read_b64_tr_b16 v[90:91], v4 offset:2560
    v_mfma_f32_32x32x16_bf16 v[32:47], v[80:83], v[140:143], v[32:47]
    ds_read_b64_tr_b16 v[92:93], v5 offset:2048
    ds_read_b64_tr_b16 v[94:95], v5 offset:2560
    v_mfma_f32_32x32x16_bf16 v[48:63], v[84:87], v[136:139], v[48:63]
    buffer_load_dwordx4 v[128:131], v3, s[44:47], s53 offen sc1
    v_mfma_f32_32x32x16_bf16 v[64:79], v[84:87], v[140:143], v[64:79]
    buffer_load_dwordx4 v[132:135], v6, s[44:47], s53 offen sc1
    s_add_u32 s53, s53, 16384
    s_waitcnt lgkmcnt(0)
    s_add_u32 m0, s50, 2048
    s_add_u32 s52, s51, 28672
    buffer_load_dwordx4 v2, s[40:43], s51 offen lds
    s_add_u32 m0, s50, 3072
    s_add_u32 s51, s51, 57344
    buffer_load_dwordx4 v2, s[40:43], s52 offen lds
    s_waitcnt vmcnt(8)
    v_mfma_f32_32x32x16_bf16 v[16:31], v[88:91], v[144:147], v[16:31]
    ds_read_b64_tr_b16 v[80:81], v4 offset:4096
    ds_read_b64_tr_b16 v[82:83], v4 offset:4608
    v_mfma_f32_32x32x16_bf16 v[32:47], v[88:91], v[148:151], v[32:47]
    ds_read_b64_tr_b16 v[84:85], v5 offset:4096
    ds_read_b64_tr_b16 v[86:87], v5 offset:4608
    v_mfma_f32_32x32x16_bf16 v[48:63], v[92:95], v[144:147], v[48:63]
    buffer_load_dwordx4 v[136:139], v3, s[44:47], s53 offen sc1
    v_mfma_f32_32x32x16_bf16 v[64:79], v[92:95], v[148:151], v[64:79]
    buffer_load_dwordx4 v[140:143], v6, s[44:47], s53 offen sc1
    s_add_u32 s53, s53, 16384
    s_waitcnt lgkmcnt(0)
    s_add_u32 m0, s50, 4096
    s_add_u32 s52, s51, 28672
    buffer_load_dwordx4 v2, s[40:43], s51 offen lds
    s_add_u32 m0, s50, 5120
    s_add_u32 s51, s51, 57344
    buffer_load_dwordx4 v2, s[40:43], s52 offen lds
    s_waitcnt vmcnt(8)
    v_mfma_f32_32x32x16_bf16 v[16:31], v[80:83], v[152:155], v[16:31]
    ds_read_b64_tr_b16 v[88:89], v4 offset:0
    ds_read_b64_tr_b16 v[90:91], v4 offset:512
    v_mfma_f32_32x32x16_bf16 v[32:47], v[80:83], v[156:159], v[32:47]
    ds_read_b64_tr_b16 v[92:93], v5 offset:0
    ds_read_b64_tr_b16 v[94:95], v5 offset:512
    v_mfma_f32_32x32x16_bf16 v[48:63], v[84:87], v[152:155], v[48:63]
    buffer_load_dwordx4 v[144:147], v3, s[44:47], s53 offen sc1
    v_mfma_f32_32x32x16_bf16 v[64:79], v[84:87], v[156:159], v[64:79]
    buffer_load_dwordx4 v[148:151], v6, s[44:47], s53 offen sc1
    s_add_u32 s53, s53, 16384
    s_waitcnt lgkmcnt(0)
    s_add_u32 m0, s50, 0
    s_add_u32 s52, s51, 28672
    buffer_load_dwordx4 v2, s[40:43], s51 offen lds
    s_add_u32 m0, s50, 1024
    s_add_u32 s51, s51, 57344
    buffer_load_dwordx4 v2, s[40:43], s52 offen lds
    s_waitcnt vmcnt(8)
    s_nop 0
    v_mfma_f32_32x32x16_bf16 v[16:31], v[88:91], v[160:163], v[16:31]
    ds_read_b64_tr_b16 v[80:81], v4 offset:2048
    ds_read_b64_tr_b16 v[82:83], v4 offset:2560
    v_mfma_f32_32x32x16_bf16 v[32:47], v[88:91], v[164:167], v[32:47]
    ds_read_b64_tr_b16 v[84:85], v5 offset:2048
    ds_read_b64_tr_b16 v[86:87], v5 offset:2560
    v_mfma_f32_32x32x16_bf16 v[48:63], v[92:95], v[160:163], v[48:63]
    buffer_load_dwordx4 v[152:155], v3, s[44:47], s53 offen sc1
    v_mfma_f32_32x32x16_bf16 v[64:79], v[92:95], v[164:167], v[64:79]
    buffer_load_dwordx4 v[156:159], v6, s[44:47], s53 offen sc1
    s_add_u32 s53, s53, 16384
    s_waitcnt lgkmcnt(0)
    s_add_u32 m0, s50, 2048
    s_add_u32 s52, s51, 28672
    buffer_load_dwordx4 v2, s[40:43], s51 offen lds
    s_add_u32 m0, s50, 3072
    s_add_u32 s51, s51, 57344
    buffer_load_dwordx4 v2, s[40:43], s52 offen lds
    s_waitcnt vmcnt(8)
    v_mfma_f32_32x32x16_bf16 v[16:31], v[80:83], v[128:131], v[16:31]
    ds_read_b64_tr_b16 v[88:89], v4 offset:4096
    ds_read_b64_tr_b16 v[90:91], v4 offset:4608
    v_mfma_f32_32x32x16_bf16 v[32:47], v[80:83], v[132:135], v[32:47]
    ds_read_b64_tr_b16 v[92:93], v5 offset:4096
    ds_read_b64_tr_b16 v[94:95], v5 offset:4608
    v_mfma_f32_32x32x16_bf16 v[48:63], v[84:87], v[128:131], v[48:63]
    buffer_load_dwordx4 v[160:163], v3, s[44:47], s53 offen sc1
    v_mfma_f32_32x32x16_bf16 v[64:79], v[84:87], v[132:135], v[64:79]
    buffer_load_dwordx4 v[164:167], v6, s[44:47], s53 offen sc1
    s_add_u32 s53, s53, 16384
    s_waitcnt lgkmcnt(0)
    s_add_u32 m0, s50, 4096
    s_add_u32 s52, s51, 28672
    buffer_load_dwordx4 v2, s[40:43], s51 offen lds
    s_add_u32 m0, s50, 5120
    s_add_u32 s51, s51, 57344
    buffer_load_dwordx4 v2, s[40:43], s52 offen lds
    s_waitcnt vmcnt(8)
    v_mfma_f32_32x32x16_bf16 v[16:31], v[88:91], v[136:139], v[16:31]
    ds_read_b64_tr_b16 v[80:81], v4 offset:0
    ds_read_b64_tr_b16 v[82:83], v4 offset:512
    v_mfma_f32_32x32x16_bf16 v[32:47], v[88:91], v[140:143], v[32:47]
    ds_read_b64_tr_b16 v[84:85], v5 offset:0
    ds_read_b64_tr_b16 v[86:87], v5 offset:512
    v_mfma_f32_32x32x16_bf16 v[48:63], v[92:95], v[136:139], v[48:63]
    buffer_load_dwordx4 v[128:131], v3, s[44:47], s53 offen sc1
    v_mfma_f32_32x32x16_bf16 v[64:79], v[92:95], v[140:143], v[64:79]
    buffer_load_dwordx4 v[132:135], v6, s[44:47], s53 offen sc1
    s_add_u32 s53, s53, 16384
    s_waitcnt lgkmcnt(0)
    s_add_u32 m0, s50, 0
    s_add_u32 s52, s51, 28672
    buffer_load_dwordx4 v2, s[40:43], s51 offen lds
    s_add_u32 m0, s50, 1024
    s_add_u32 s51, s51, 57344
    buffer_load_dwordx4 v2, s[40:43], s52 offen lds
    s_waitcnt vmcnt(8)
    s_nop 0
    v_mfma_f32_32x32x16_bf16 v[16:31], v[80:83], v[144:147], v[16:31]
    ds_read_b64_tr_b16 v[88:89], v4 offset:2048
    ds_read_b64_tr_b16 v[90:91], v4 offset:2560
    v_mfma_f32_32x32x16_bf16 v[32:47], v[80:83], v[148:151], v[32:47]
    ds_read_b64_tr_b16 v[92:93], v5 offset:2048
    ds_read_b64_tr_b16 v[94:95], v5 offset:2560
    v_mfma_f32_32x32x16_bf16 v[48:63], v[84:87], v[144:147], v[48:63]
    buffer_load_dwordx4 v[136:139], v3, s[44:47], s53 offen sc1
    v_mfma_f32_32x32x16_bf16 v[64:79], v[84:87], v[148:151], v[64:79]
    buffer_load_dwordx4 v[140:143], v6, s[44:47], s53 offen sc1
    s_add_u32 s53, s53, 16384
    s_waitcnt lgkmcnt(0)
    s_add_u32 m0, s50, 2048
    s_add_u32 s52, s51, 28672
    buffer_load_dwordx4 v2, s[40:43], s51 offen lds
    s_add_u32 m0, s50, 3072
    s_add_u32 s51, s51, 57344
    buffer_load_dwordx4 v2, s[40:43], s52 offen lds
    s_waitcnt vmcnt(8)
    v_mfma_f32_32x32x16_bf16 v[16:31], v[88:91], v[152:155], v[16:31]
    ds_read_b64_tr_b16 v[80:81], v4 offset:4096
    ds_read_b64_tr_b16 v[82:83], v4 offset:4608
    v_mfma_f32_32x32x16_bf16 v[32:47], v[88:91], v[156:159], v[32:47]
    ds_read_b64_tr_b16 v[84:85], v5 offset:4096
    ds_read_b64_tr_b16 v[86:87], v5 offset:4608
    v_mfma_f32_32x32x16_bf16 v[48:63], v[92:95], v[152:155], v[48:63]
    buffer_load_dwordx4 v[144:147], v3, s[44:47], s53 offen sc1
    v_mfma_f32_32x32x16_bf16 v[64:79], v[92:95], v[156:159], v[64:79]
    buffer_load_dwordx4 v[148:151], v6, s[44:47], s53 offen sc1
    s_add_u32 s53, s53, 16384
    s_waitcnt lgkmcnt(0)
    s_add_u32 m0, s50, 4096
    s_add_u32 s52, s51, 28672
    buffer_load_dwordx4 v2, s[40:43], s51 offen lds
    s_add_u32 m0, s50, 5120
    s_add_u32 s51, s51, 57344
    buffer_load_dwordx4 v2, s[40:43], s52 offen lds
    s_waitcnt vmcnt(8)
    v_mfma_f32_32x32x16_bf16 v[16:31], v[80:83], v[160:163], v[16:31]
    ds_read_b64_tr_b16 v[88:89], v4 offset:0
    ds_read_b64_tr_b16 v[90:91], v4 offset:512
    v_mfma_f32_32x32x16_bf16 v[32:47], v[80:83], v[164:167], v[32:47]
    ds_read_b64_tr_b16 v[92:93], v5 offset:0
    ds_read_b64_tr_b16 v[94:95], v5 offset:512
    v_mfma_f32_32x32x16_bf16 v[48:63], v[84:87], v[160:163], v[48:63]
    buffer_load_dwordx4 v[152:155], v3, s[44:47], s53 offen sc1
    v_mfma_f32_32x32x16_bf16 v[64:79], v[84:87], v[164:167], v[64:79]
    buffer_load_dwordx4 v[156:159], v6, s[44:47], s53 offen sc1
    s_add_u32 s53, s53, 16384
    s_waitcnt lgkmcnt(0)
    s_add_u32 m0, s50, 0
    s_add_u32 s52, s51, 28672
    buffer_load_dwordx4 v2, s[40:43], s51 offen lds
    s_add_u32 m0, s50, 1024
    s_add_u32 s51, s51, 57344
    buffer_load_dwordx4 v2, s[40:43], s52 offen lds
    s_waitcnt vmcnt(8)
    s_nop 0
    v_mfma_f32_32x32x16_bf16 v[16:31], v[88:91], v[128:131], v[16:31]
    ds_read_b64_tr_b16 v[80:81], v4 offset:2048
    ds_read_b64_tr_b16 v[82:83], v4 offset:2560
    v_mfma_f32_32x32x16_bf16 v[32:47], v[88:91], v[132:135], v[32:47]
    ds_read_b64_tr_b16 v[84:85], v5 offset:2048
    ds_read_b64_tr_b16 v[86:87], v5 offset:2560
    v_mfma_f32_32x32x16_bf16 v[48:63], v[92:95], v[128:131], v[48:63]
    buffer_load_dwordx4 v[160:163], v3, s[44:47], s53 offen sc1
    v_mfma_f32_32x32x16_bf16 v[64:79], v[92:95], v[132:135], v[64:79]
    buffer_load_dwordx4 v[164:167], v6, s[44:47], s53 offen sc1
    s_add_u32 s53, s53, 16384
    s_waitcnt lgkmcnt(0)
    s_add_u32 m0, s50, 2048
    s_add_u32 s52, s51, 28672
    buffer_load_dwordx4 v2, s[40:43], s51 offen lds
    s_add_u32 m0, s50, 3072
    s_add_u32 s51, s51, 57344
    buffer_load_dwordx4 v2, s[40:43], s52 offen lds
    s_waitcnt vmcnt(8)
    v_mfma_f32_32x32x16_bf16 v[16:31], v[80:83], v[136:139], v[16:31]
    ds_read_b64_tr_b16 v[88:89], v4 offset:4096
    ds_read_b64_tr_b16 v[90:91], v4 offset:4608
    v_mfma_f32_32x32x16_bf16 v[32:47], v[80:83], v[140:143], v[32:47]
    ds_read_b64_tr_b16 v[92:93], v5 offset:4096
    ds_read_b64_tr_b16 v[94:95], v5 offset:4608
    v_mfma_f32_32x32x16_bf16 v[48:63], v[84:87], v[136:139], v[48:63]
    buffer_load_dwordx4 v[128:131], v3, s[44:47], s53 offen sc1
    v_mfma_f32_32x32x16_bf16 v[64:79], v[84:87], v[140:143], v[64:79]
    buffer_load_dwordx4 v[132:135], v6, s[44:47], s53 offen sc1
    s_add_u32 s53, s53, 16384
    s_waitcnt lgkmcnt(0)
    s_add_u32 m0, s50, 4096
    s_add_u32 s52, s51, 28672
    buffer_load_dwordx4 v2, s[40:43], s51 offen lds
    s_add_u32 m0, s50, 5120
    s_add_u32 s51, s51, 57344
    buffer_load_dwordx4 v2, s[40:43], s52 offen lds
    s_waitcnt vmcnt(8)
    v_mfma_f32_32x32x16_bf16 v[16:31], v[88:91], v[144:147], v[16:31]
    ds_read_b64_tr_b16 v[80:81], v4 offset:0
    ds_read_b64_tr_b16 v[82:83], v4 offset:512
    v_mfma_f32_32x32x16_bf16 v[32:47], v[88:91], v[148:151], v[32:47]
    ds_read_b64_tr_b16 v[84:85], v5 offset:0
    ds_read_b64_tr_b16 v[86:87], v5 offset:512
    v_mfma_f32_32x32x16_bf16 v[48:63], v[92:95], v[144:147], v[48:63]
    buffer_load_dwordx4 v[136:139], v3, s[44:47], s53 offen sc1
    v_mfma_f32_32x32x16_bf16 v[64:79], v[92:95], v[148:151], v[64:79]
    buffer_load_dwordx4 v[140:143], v6, s[44:47], s53 offen sc1
    s_add_u32 s53, s53, 16384
    s_waitcnt lgkmcnt(0)
    s_add_u32 m0, s50, 0
    s_add_u32 s52, s51, 28672
    buffer_load_dwordx4 v2, s[40:43], s51 offen lds
    s_add_u32 m0, s50, 1024
    s_add_u32 s51, s51, 57344
    buffer_load_dwordx4 v2, s[40:43], s52 offen lds
    s_waitcnt vmcnt(8)
    s_nop 0
    v_mfma_f32_32x32x16_bf16 v[16:31], v[80:83], v[152:155], v[16:31]
    ds_read_b64_tr_b16 v[88:89], v4 offset:2048
    ds_read_b64_tr_b16 v[90:91], v4 offset:2560
    v_mfma_f32_32x32x16_bf16 v[32:47], v[80:83], v[156:159], v[32:47]
    ds_read_b64_tr_b16 v[92:93], v5 offset:2048
    ds_read_b64_tr_b16 v[94:95], v5 offset:2560
    v_mfma_f32_32x32x16_bf16 v[48:63], v[84:87], v[152:155], v[48:63]
    buffer_load_dwordx4 v[144:147], v3, s[44:47], s53 offen sc1
    v_mfma_f32_32x32x16_bf16 v[64:79], v[84:87], v[156:159], v[64:79]
    buffer_load_dwordx4 v[148:151], v6, s[44:47], s53 offen sc1
    s_add_u32 s53, s53, 16384
    s_waitcnt lgkmcnt(0)
    s_add_u32 m0, s50, 2048
    s_add_u32 s52, s51, 28672
    buffer_load_dwordx4 v2, s[40:43], s51 offen lds
    s_add_u32 m0, s50, 3072
    s_add_u32 s51, s51, 57344
    buffer_load_dwordx4 v2, s[40:43], s52 offen lds
    s_waitcnt vmcnt(8)
    v_mfma_f32_32x32x16_bf16 v[16:31], v[88:91], v[160:163], v[16:31]
    ds_read_b64_tr_b16 v[80:81], v4 offset:4096
    ds_read_b64_tr_b16 v[82:83], v4 offset:4608
    v_mfma_f32_32x32x16_bf16 v[32:47], v[88:91], v[164:167], v[32:47]
    ds_read_b64_tr_b16 v[84:85], v5 offset:4096
    ds_read_b64_tr_b16 v[86:87], v5 offset:4608
    v_mfma_f32_32x32x16_bf16 v[48:63], v[92:95], v[160:163], v[48:63]
    buffer_load_dwordx4 v[152:155], v3, s[44:47], s53 offen sc1
    v_mfma_f32_32x32x16_bf16 v[64:79], v[92:95], v[164:167], v[64:79]
    buffer_load_dwordx4 v[156:159], v6, s[44:47], s53 offen sc1
    s_add_u32 s53, s53, 16384
    s_waitcnt lgkmcnt(0)
    s_add_u32 m0, s50, 4096
    s_add_u32 s52, s51, 28672
    buffer_load_dwordx4 v2, s[40:43], s51 offen lds
    s_add_u32 m0, s50, 5120
    s_add_u32 s51, s51, 57344
    buffer_load_dwordx4 v2, s[40:43], s52 offen lds
    s_waitcnt vmcnt(8)
    v_mfma_f32_32x32x16_bf16 v[16:31], v[80:83], v[128:131], v[16:31]
    ds_read_b64_tr_b16 v[88:89], v4 offset:0
    ds_read_b64_tr_b16 v[90:91], v4 offset:512
    v_mfma_f32_32x32x16_bf16 v[32:47], v[80:83], v[132:135], v[32:47]
    ds_read_b64_tr_b16 v[92:93], v5 offset:0
    ds_read_b64_tr_b16 v[94:95], v5 offset:512
    v_mfma_f32_32x32x16_bf16 v[48:63], v[84:87], v[128:131], v[48:63]
    buffer_load_dwordx4 v[160:163], v3, s[44:47], s53 offen sc1
    v_mfma_f32_32x32x16_bf16 v[64:79], v[84:87], v[132:135], v[64:79]
    buffer_load_dwordx4 v[164:167], v6, s[44:47], s53 offen sc1
    s_add_u32 s53, s53, 16384
    s_waitcnt lgkmcnt(0)
    s_add_u32 m0, s50, 0
    s_add_u32 s52, s51, 28672
    buffer_load_dwordx4 v2, s[40:43], s51 offen lds
    s_add_u32 m0, s50, 1024
    s_add_u32 s51, s51, 57344
    buffer_load_dwordx4 v2, s[40:43], s52 offen lds
    s_waitcnt vmcnt(8)
    s_nop 0
    v_mfma_f32_32x32x16_bf16 v[16:31], v[88:91], v[136:139], v[16:31]
    ds_read_b64_tr_b16 v[80:81], v4 offset:2048
    ds_read_b64_tr_b16 v[82:83], v4 offset:2560
    v_mfma_f32_32x32x16_bf16 v[32:47], v[88:91], v[140:143], v[32:47]
    ds_read_b64_tr_b16 v[84:85], v5 offset:2048
    ds_read_b64_tr_b16 v[86:87], v5 offset:2560
    v_mfma_f32_32x32x16_bf16 v[48:63], v[92:95], v[136:139], v[48:63]
    buffer_load_dwordx4 v[128:131], v3, s[44:47], s53 offen sc1
    v_mfma_f32_32x32x16_bf16 v[64:79], v[92:95], v[140:143], v[64:79]
    buffer_load_dwordx4 v[132:135], v6, s[44:47], s53 offen sc1
    s_add_u32 s53, s53, 16384
    s_waitcnt lgkmcnt(0)
    s_add_u32 m0, s50, 2048
    s_add_u32 s52, s51, 28672
    buffer_load_dwordx4 v2, s[40:43], s51 offen lds
    s_add_u32 m0, s50, 3072
    s_add_u32 s51, s51, 57344
    buffer_load_dwordx4 v2, s[40:43], s52 offen lds
    s_waitcnt vmcnt(8)
    v_mfma_f32_32x32x16_bf16 v[16:31], v[80:83], v[144:147], v[16:31]
    ds_read_b64_tr_b16 v[88:89], v4 offset:4096
    ds_read_b64_tr_b16 v[90:91], v4 offset:4608
    v_mfma_f32_32x32x16_bf16 v[32:47], v[80:83], v[148:151], v[32:47]
    ds_read_b64_tr_b16 v[92:93], v5 offset:4096
    ds_read_b64_tr_b16 v[94:95], v5 offset:4608
    v_mfma_f32_32x32x16_bf16 v[48:63], v[84:87], v[144:147], v[48:63]
    buffer_load_dwordx4 v[136:139], v3, s[44:47], s53 offen sc1
    v_mfma_f32_32x32x16_bf16 v[64:79], v[84:87], v[148:151], v[64:79]
    buffer_load_dwordx4 v[140:143], v6, s[44:47], s53 offen sc1
    s_add_u32 s53, s53, 16384
    s_waitcnt lgkmcnt(0)
    s_add_u32 m0, s50, 4096
    s_add_u32 s52, s51, 28672
    buffer_load_dwordx4 v2, s[40:43], s51 offen lds
    s_add_u32 m0, s50, 5120
    s_add_u32 s51, s51, 57344
    buffer_load_dwordx4 v2, s[40:43], s52 offen lds
    s_waitcnt vmcnt(8)
    v_mfma_f32_32x32x16_bf16 v[16:31], v[88:91], v[152:155], v[16:31]
    ds_read_b64_tr_b16 v[80:81], v4 offset:0
    ds_read_b64_tr_b16 v[82:83], v4 offset:512
    v_mfma_f32_32x32x16_bf16 v[32:47], v[88:91], v[156:159], v[32:47]
    ds_read_b64_tr_b16 v[84:85], v5 offset:0
    ds_read_b64_tr_b16 v[86:87], v5 offset:512
    v_mfma_f32_32x32x16_bf16 v[48:63], v[92:95], v[152:155], v[48:63]
    buffer_load_dwordx4 v[144:147], v3, s[44:47], s53 offen sc1
    v_mfma_f32_32x32x16_bf16 v[64:79], v[92:95], v[156:159], v[64:79]
    buffer_load_dwordx4 v[148:151], v6, s[44:47], s53 offen sc1
    s_add_u32 s53, s53, 16384
    s_waitcnt lgkmcnt(0)
    s_add_u32 m0, s50, 0
    s_add_u32 s52, s51, 28672
    buffer_load_dwordx4 v2, s[40:43], s51 offen lds
    s_add_u32 m0, s50, 1024
    s_add_u32 s51, s51, 57344
    buffer_load_dwordx4 v2, s[40:43], s52 offen lds
    s_waitcnt vmcnt(8)
    s_nop 0
    v_mfma_f32_32x32x16_bf16 v[16:31], v[80:83], v[160:163], v[16:31]
    ds_read_b64_tr_b16 v[88:89], v4 offset:2048
    ds_read_b64_tr_b16 v[90:91], v4 offset:2560
    v_mfma_f32_32x32x16_bf16 v[32:47], v[80:83], v[164:167], v[32:47]
    ds_read_b64_tr_b16 v[92:93], v5 offset:2048
    ds_read_b64_tr_b16 v[94:95], v5 offset:2560
    v_mfma_f32_32x32x16_bf16 v[48:63], v[84:87], v[160:163], v[48:63]
    buffer_load_dwordx4 v[152:155], v3, s[44:47], s53 offen sc1
    v_mfma_f32_32x32x16_bf16 v[64:79], v[84:87], v[164:167], v[64:79]
    buffer_load_dwordx4 v[156:159], v6, s[44:47], s53 offen sc1
    s_add_u32 s53, s53, 16384
    s_waitcnt lgkmcnt(0)
    s_add_u32 m0, s50, 2048
    s_add_u32 s52, s51, 28672
    buffer_load_dwordx4 v2, s[40:43], s51 offen lds
    s_add_u32 m0, s50, 3072
    s_add_u32 s51, s51, 57344
    buffer_load_dwordx4 v2, s[40:43], s52 offen lds
    s_waitcnt vmcnt(8)
    v_mfma_f32_32x32x16_bf16 v[16:31], v[88:91], v[128:131], v[16:31]
    ds_read_b64_tr_b16 v[80:81], v4 offset:4096
    ds_read_b64_tr_b16 v[82:83], v4 offset:4608
    v_mfma_f32_32x32x16_bf16 v[32:47], v[88:91], v[132:135], v[32:47]
    ds_read_b64_tr_b16 v[84:85], v5 offset:4096
    ds_read_b64_tr_b16 v[86:87], v5 offset:4608
    v_mfma_f32_32x32x16_bf16 v[48:63], v[92:95], v[128:131], v[48:63]
    buffer_load_dwordx4 v[160:163], v3, s[44:47], s53 offen sc1
    v_mfma_f32_32x32x16_bf16 v[64:79], v[92:95], v[132:135], v[64:79]
    buffer_load_dwordx4 v[164:167], v6, s[44:47], s53 offen sc1
    s_add_u32 s53, s53, 16384
    s_waitcnt lgkmcnt(0)
    s_add_u32 m0, s50, 4096
    s_add_u32 s52, s51, 28672
    buffer_load_dwordx4 v2, s[40:43], s51 offen lds
    s_add_u32 m0, s50, 5120
    s_add_u32 s51, s51, 57344
    buffer_load_dwordx4 v2, s[40:43], s52 offen lds
    s_waitcnt vmcnt(8)
    v_mfma_f32_32x32x16_bf16 v[16:31], v[80:83], v[136:139], v[16:31]
    ds_read_b64_tr_b16 v[88:89], v4 offset:0
    ds_read_b64_tr_b16 v[90:91], v4 offset:512
    v_mfma_f32_32x32x16_bf16 v[32:47], v[80:83], v[140:143], v[32:47]
    ds_read_b64_tr_b16 v[92:93], v5 offset:0
    ds_read_b64_tr_b16 v[94:95], v5 offset:512
    v_mfma_f32_32x32x16_bf16 v[48:63], v[84:87], v[136:139], v[48:63]
    buffer_load_dwordx4 v[128:131], v3, s[44:47], s53 offen sc1
    v_mfma_f32_32x32x16_bf16 v[64:79], v[84:87], v[140:143], v[64:79]
    buffer_load_dwordx4 v[132:135], v6, s[44:47], s53 offen sc1
    s_add_u32 s53, s53, 16384
    s_waitcnt lgkmcnt(0)
    s_add_u32 m0, s50, 0
    s_add_u32 s52, s51, 28672
    buffer_load_dwordx4 v2, s[40:43], s51 offen lds
    s_add_u32 m0, s50, 1024
    s_add_u32 s51, s51, 57344
    buffer_load_dwordx4 v2, s[40:43], s52 offen lds
    s_waitcnt vmcnt(8)
    s_nop 0
    v_mfma_f32_32x32x16_bf16 v[16:31], v[88:91], v[144:147], v[16:31]
    ds_read_b64_tr_b16 v[80:81], v4 offset:2048
    ds_read_b64_tr_b16 v[82:83], v4 offset:2560
    v_mfma_f32_32x32x16_bf16 v[32:47], v[88:91], v[148:151], v[32:47]
    ds_read_b64_tr_b16 v[84:85], v5 offset:2048
    ds_read_b64_tr_b16 v[86:87], v5 offset:2560
    v_mfma_f32_32x32x16_bf16 v[48:63], v[92:95], v[144:147], v[48:63]
    buffer_load_dwordx4 v[136:139], v3, s[44:47], s53 offen sc1
    v_mfma_f32_32x32x16_bf16 v[64:79], v[92:95], v[148:151], v[64:79]
    buffer_load_dwordx4 v[140:143], v6, s[44:47], s53 offen sc1
    s_add_u32 s53, s53, 16384
    s_waitcnt lgkmcnt(0)
    s_add_u32 m0, s50, 2048
    s_add_u32 s52, s51, 28672
    buffer_load_dwordx4 v2, s[40:43], s51 offen lds
    s_add_u32 m0, s50, 3072
    s_add_u32 s51, s51, 57344
    buffer_load_dwordx4 v2, s[40:43], s52 offen lds
    s_waitcnt vmcnt(8)
    v_mfma_f32_32x32x16_bf16 v[16:31], v[80:83], v[152:155], v[16:31]
    ds_read_b64_tr_b16 v[88:89], v4 offset:4096
    ds_read_b64_tr_b16 v[90:91], v4 offset:4608
    v_mfma_f32_32x32x16_bf16 v[32:47], v[80:83], v[156:159], v[32:47]
    ds_read_b64_tr_b16 v[92:93], v5 offset:4096
    ds_read_b64_tr_b16 v[94:95], v5 offset:4608
    v_mfma_f32_32x32x16_bf16 v[48:63], v[84:87], v[152:155], v[48:63]
    v_mfma_f32_32x32x16_bf16 v[64:79], v[84:87], v[156:159], v[64:79]
    s_waitcnt lgkmcnt(0)
    s_waitcnt vmcnt(4)
    v_mfma_f32_32x32x16_bf16 v[16:31], v[88:91], v[160:163], v[16:31]
    ds_read_b64_tr_b16 v[80:81], v4 offset:0
    ds_read_b64_tr_b16 v[82:83], v4 offset:512
    v_mfma_f32_32x32x16_bf16 v[32:47], v[88:91], v[164:167], v[32:47]
    ds_read_b64_tr_b16 v[84:85], v5 offset:0
    ds_read_b64_tr_b16 v[86:87], v5 offset:512
    v_mfma_f32_32x32x16_bf16 v[48:63], v[92:95], v[160:163], v[48:63]
    v_mfma_f32_32x32x16_bf16 v[64:79], v[92:95], v[164:167], v[64:79]
    s_waitcnt lgkmcnt(0)
    s_waitcnt vmcnt(0)
    v_mfma_f32_32x32x16_bf16 v[16:31], v[80:83], v[128:131], v[16:31]
    ds_read_b64_tr_b16 v[88:89], v4 offset:2048
    ds_read_b64_tr_b16 v[90:91], v4 offset:2560
    v_mfma_f32_32x32x16_bf16 v[32:47], v[80:83], v[132:135], v[32:47]
    ds_read_b64_tr_b16 v[92:93], v5 offset:2048
    ds_read_b64_tr_b16 v[94:95], v5 offset:2560
    v_mfma_f32_32x32x16_bf16 v[48:63], v[84:87], v[128:131], v[48:63]
    v_mfma_f32_32x32x16_bf16 v[64:79], v[84:87], v[132:135], v[64:79]
    s_waitcnt lgkmcnt(0)
    s_waitcnt vmcnt(2)
    v_mfma_f32_32x32x16_bf16 v[16:31], v[88:91], v[136:139], v[16:31]
    v_mfma_f32_32x32x16_bf16 v[32:47], v[88:91], v[140:143], v[32:47]
    v_mfma_f32_32x32x16_bf16 v[48:63], v[92:95], v[136:139], v[48:63]
    v_mfma_f32_32x32x16_bf16 v[64:79], v[92:95], v[140:143], v[64:79]
    s_setprio 3
    s_nop 8
    ds_write_b128 v8, v[32:35] offset:0
    ds_write_b128 v8, v[36:39] offset:1024
    ds_write_b128 v8, v[48:51] offset:2048
    ds_write_b128 v8, v[52:55] offset:3072
    ds_write_b128 v8, v[64:67] offset:4096
    ds_write_b128 v8, v[68:71] offset:5120
    v_mov_b32 v7, 1
    s_waitcnt lgkmcnt(0)
    ds_write_b32 v12, v7
    v_mov_b32 v104, 0xc0135761
    v_mov_b32 v105, v104
    v_mov_b32 v106, 1.0
    v_mov_b32 v107, 1.0
L_w_81:
    ds_read_b32 v7, v13
    s_waitcnt lgkmcnt(0)
    v_cmp_le_u32 vcc, 1, v7
    s_cmp_eq_u64 vcc, -1
    s_cbranch_scc1 L_wd_82
    s_sleep 0
    s_sub_u32 s70, s70, 1
    s_cmp_gt_i32 s70, 0
    s_cbranch_scc1 L_w_81
L_wd_82:
    ds_read_b128 v[80:83], v9 offset:0
    ds_read_b128 v[84:87], v9 offset:1024
    ds_read_b128 v[88:91], v10 offset:0
    ds_read_b128 v[92:95], v10 offset:1024
    ds_read_b128 v[96:99], v11 offset:0
    ds_read_b128 v[100:103], v11 offset:1024
    s_waitcnt lgkmcnt(0)
    ds_write_b128 v9, v[40:43] offset:0
    ds_write_b128 v9, v[44:47] offset:1024
    ds_write_b128 v10, v[56:59] offset:0
    ds_write_b128 v10, v[60:63] offset:1024
    ds_write_b128 v11, v[72:75] offset:0
    ds_write_b128 v11, v[76:79] offset:1024
    v_mov_b32 v7, 2
    s_waitcnt lgkmcnt(0)
    ds_write_b32 v12, v7
    v_pk_add_f32 v[16:17], v[16:17], v[80:81]
    v_pk_add_f32 v[88:89], v[88:89], v[96:97]
    v_pk_add_f32 v[18:19], v[18:19], v[82:83]
    v_pk_add_f32 v[90:91], v[90:91], v[98:99]
    v_pk_add_f32 v[20:21], v[20:21], v[84:85]
    v_pk_add_f32 v[92:93], v[92:93], v[100:101]
    v_pk_add_f32 v[22:23], v[22:23], v[86:87]
    v_pk_add_f32 v[94:95], v[94:95], v[102:103]
    v_pk_add_f32 v[16:17], v[16:17], v[88:89]
    v_pk_add_f32 v[18:19], v[18:19], v[90:91]
    v_pk_add_f32 v[20:21], v[20:21], v[92:93]
    v_pk_add_f32 v[22:23], v[22:23], v[94:95]
L_w_83:
    ds_read_b32 v7, v13
    s_waitcnt lgkmcnt(0)
    v_cmp_le_u32 vcc, 2, v7
    s_cmp_eq_u64 vcc, -1
    s_cbranch_scc1 L_wd_84
    s_sleep 0
    s_sub_u32 s70, s70, 1
    s_cmp_gt_i32 s70, 0
    s_cbranch_scc1 L_w_83
L_wd_84:
    ds_read_b128 v[80:83], v8 offset:0
    ds_read_b128 v[84:87], v8 offset:1024
    ds_read_b128 v[88:91], v8 offset:2048
    ds_read_b128 v[92:95], v8 offset:3072
    ds_read_b128 v[96:99], v8 offset:4096
    ds_read_b128 v[100:103], v8 offset:5120
    s_waitcnt lgkmcnt(0)
    s_nop 0
    v_pk_add_f32 v[24:25], v[24:25], v[80:81]
    v_pk_add_f32 v[88:89], v[88:89], v[96:97]
    v_pk_add_f32 v[26:27], v[26:27], v[82:83]
    v_pk_add_f32 v[90:91], v[90:91], v[98:99]
    v_pk_add_f32 v[28:29], v[28:29], v[84:85]
    v_pk_add_f32 v[92:93], v[92:93], v[100:101]
    v_pk_add_f32 v[30:31], v[30:31], v[86:87]
    v_pk_add_f32 v[94:95], v[94:95], v[102:103]
    v_pk_add_f32 v[24:25], v[24:25], v[88:89]
    v_pk_add_f32 v[26:27], v[26:27], v[90:91]
    v_pk_add_f32 v[28:29], v[28:29], v[92:93]
    v_pk_add_f32 v[30:31], v[30:31], v[94:95]
    v_pk_mul_f32 v[80:81], v[16:17], v[16:17]
    v_pk_mul_f32 v[82:83], v[18:19], v[18:19]
    v_pk_mul_f32 v[84:85], v[20:21], v[20:21]
    v_pk_mul_f32 v[86:87], v[22:23], v[22:23]
    v_pk_mul_f32 v[88:89], v[24:25], v[24:25]
    v_pk_mul_f32 v[90:91], v[26:27], v[26:27]
    v_pk_mul_f32 v[92:93], v[28:29], v[28:29]
    v_pk_mul_f32 v[94:95], v[30:31], v[30:31]
    v_pk_fma_f32 v[80:81], v[80:81], s[48:49], v[104:105]
    v_pk_fma_f32 v[82:83], v[82:83], s[48:49], v[104:105]
    v_pk_fma_f32 v[84:85], v[84:85], s[48:49], v[104:105]
    v_pk_fma_f32 v[86:87], v[86:87], s[48:49], v[104:105]
    v_pk_fma_f32 v[88:89], v[88:89], s[48:49], v[104:105]
    v_pk_fma_f32 v[90:91], v[90:91], s[48:49], v[104:105]
    v_pk_fma_f32 v[92:93], v[92:93], s[48:49], v[104:105]
    v_pk_fma_f32 v[94:95], v[94:95], s[48:49], v[104:105]
    v_pk_mul_f32 v[80:81], v[80:81], v[16:17]
    v_pk_mul_f32 v[82:83], v[82:83], v[18:19]
    v_pk_mul_f32 v[84:85], v[84:85], v[20:21]
    v_pk_mul_f32 v[86:87], v[86:87], v[22:23]
    v_pk_mul_f32 v[88:89], v[88:89], v[24:25]
    v_pk_mul_f32 v[90:91], v[90:91], v[26:27]
    v_pk_mul_f32 v[92:93], v[92:93], v[28:29]
    v_pk_mul_f32 v[94:95], v[94:95], v[30:31]
    v_exp_f32 v80, v80
    v_exp_f32 v81, v81
    v_exp_f32 v82, v82
    v_exp_f32 v83, v83
    v_exp_f32 v84, v84
    v_exp_f32 v85, v85
    v_exp_f32 v86, v86
    v_exp_f32 v87, v87
    v_pk_add_f32 v[80:81], v[80:81], v[106:107]
    v_pk_add_f32 v[82:83], v[82:83], v[106:107]
    v_pk_add_f32 v[84:85], v[84:85], v[106:107]
    v_pk_add_f32 v[86:87], v[86:87], v[106:107]
    v_rcp_f32 v80, v80
    v_rcp_f32 v81, v81
    v_rcp_f32 v82, v82
    v_rcp_f32 v83, v83
    v_rcp_f32 v84, v84
    v_rcp_f32 v85, v85
    v_rcp_f32 v86, v86
    v_rcp_f32 v87, v87
    v_pk_mul_f32 v[16:17], v[16:17], v[80:81]
    v_pk_mul_f32 v[18:19], v[18:19], v[82:83]
    v_pk_mul_f32 v[20:21], v[20:21], v[84:85]
    v_pk_mul_f32 v[22:23], v[22:23], v[86:87]
    v_cvt_pk_bf16_f32 v108, v16, v17
    v_cvt_pk_bf16_f32 v109, v18, v19
    v_cvt_pk_bf16_f32 v110, v20, v21
    v_cvt_pk_bf16_f32 v111, v22, v23
    buffer_store_dwordx4 v[108:111], v15, s[16:19], s68 offen sc1
    v_exp_f32 v88, v88
    v_exp_f32 v89, v89
    v_exp_f32 v90, v90
    v_exp_f32 v91, v91
    v_exp_f32 v92, v92
    v_exp_f32 v93, v93
    v_exp_f32 v94, v94
    v_exp_f32 v95, v95
    v_pk_add_f32 v[88:89], v[88:89], v[106:107]
    v_pk_add_f32 v[90:91], v[90:91], v[106:107]
    v_pk_add_f32 v[92:93], v[92:93], v[106:107]
    v_pk_add_f32 v[94:95], v[94:95], v[106:107]
    v_rcp_f32 v88, v88
    v_rcp_f32 v89, v89
    v_rcp_f32 v90, v90
    v_rcp_f32 v91, v91
    v_rcp_f32 v92, v92
    v_rcp_f32 v93, v93
    v_rcp_f32 v94, v94
    v_rcp_f32 v95, v95
    v_pk_mul_f32 v[24:25], v[24:25], v[88:89]
    v_pk_mul_f32 v[26:27], v[26:27], v[90:91]
    v_pk_mul_f32 v[28:29], v[28:29], v[92:93]
    v_pk_mul_f32 v[30:31], v[30:31], v[94:95]
    v_cvt_pk_bf16_f32 v112, v24, v25
    v_cvt_pk_bf16_f32 v113, v26, v27
    v_cvt_pk_bf16_f32 v114, v28, v29
    v_cvt_pk_bf16_f32 v115, v30, v31
    buffer_store_dwordx4 v[112:115], v15, s[16:19], s69 offen sc1
    s_add_u32 s44, s38, 0x850000
    s_addc_u32 s45, s39, 0
    s_mov_b32 s46, 0x1c0000
    s_mov_b32 s47, 0x20000
    s_waitcnt vmcnt(0)
    v_mov_b32 v7, 155752
    v_mov_b32 v8, 1
    s_mov_b64 exec, 1
    ds_add_rtn_u32 v8, v7, v8
    s_waitcnt lgkmcnt(0)
    s_mov_b64 exec, -1
    v_readfirstlane_b32 s6, v8
    s_cmp_lg_u32 s6, 3
    s_cbranch_scc1 L_nf_85
    v_mov_b32 v7, s71
    v_lshlrev_b32 v8, 14, v0
    s_mov_b64 exec, 255
    buffer_store_dword v7, v8, s[56:59], s15 offen sc1
    s_mov_b64 exec, -1
L_nf_85:
    s_branch L_g2_70
L_skip1_69:
    v_mov_b32 v7, 2
    ds_write_b32 v12, v7
    v_and_b32 v9, 7, v0
    v_lshlrev_b32 v9, 2, v9
    v_add_u32 v9, 155648, v9
L_w_86:
    ds_read_b32 v8, v9
    s_waitcnt lgkmcnt(0)
    v_cmp_le_u32 vcc, 1, v8
    s_cmp_eq_u64 vcc, -1
    s_cbranch_scc1 L_wd_87
    s_sleep 2
    s_sub_u32 s70, s70, 1
    s_cmp_gt_i32 s70, 0
    s_cbranch_scc1 L_w_86
L_wd_87:
    v_lshlrev_b32 v19, 4, v0
    s_setprio 0
    s_mul_i32 s11, s10, 1835008
    s_mul_i32 s7, s2, 7168
    s_add_u32 s11, s11, s7
    s_add_u32 s11, s11, 917504
    s_mov_b32 s6, s11
    buffer_load_dwordx4 v[20:23], v19, s[40:43], s6 offen offset:0
    buffer_load_dwordx4 v[20:23], v19, s[40:43], s6 offen offset:1024
    buffer_load_dwordx4 v[20:23], v19, s[40:43], s6 offen offset:2048
    buffer_load_dwordx4 v[20:23], v19, s[40:43], s6 offen offset:3072
    s_add_u32 s6, s6, 4096
    buffer_load_dwordx4 v[20:23], v19, s[40:43], s6 offen offset:0
    buffer_load_dwordx4 v[20:23], v19, s[40:43], s6 offen offset:1024
    buffer_load_dwordx4 v[20:23], v19, s[40:43], s6 offen offset:2048
    s_add_u32 s11, s11, 229376
    s_mov_b32 s6, s11
    buffer_load_dwordx4 v[20:23], v19, s[40:43], s6 offen offset:0
    buffer_load_dwordx4 v[20:23], v19, s[40:43], s6 offen offset:1024
    buffer_load_dwordx4 v[20:23], v19, s[40:43], s6 offen offset:2048
    buffer_load_dwordx4 v[20:23], v19, s[40:43], s6 offen offset:3072
    s_add_u32 s6, s6, 4096
    buffer_load_dwordx4 v[20:23], v19, s[40:43], s6 offen offset:0
    buffer_load_dwordx4 v[20:23], v19, s[40:43], s6 offen offset:1024
    buffer_load_dwordx4 v[20:23], v19, s[40:43], s6 offen offset:2048
    s_add_u32 s11, s11, 229376
    s_mov_b32 s6, s11
    buffer_load_dwordx4 v[20:23], v19, s[40:43], s6 offen offset:0
    buffer_load_dwordx4 v[20:23], v19, s[40:43], s6 offen offset:1024
    buffer_load_dwordx4 v[20:23], v19, s[40:43], s6 offen offset:2048
    buffer_load_dwordx4 v[20:23], v19, s[40:43], s6 offen offset:3072
    s_add_u32 s6, s6, 4096
    buffer_load_dwordx4 v[20:23], v19, s[40:43], s6 offen offset:0
    buffer_load_dwordx4 v[20:23], v19, s[40:43], s6 offen offset:1024
    buffer_load_dwordx4 v[20:23], v19, s[40:43], s6 offen offset:2048
    s_add_u32 s11, s11, 229376
    s_mov_b32 s6, s11
    buffer_load_dwordx4 v[20:23], v19, s[40:43], s6 offen offset:0
    buffer_load_dwordx4 v[20:23], v19, s[40:43], s6 offen offset:1024
    buffer_load_dwordx4 v[20:23], v19, s[40:43], s6 offen offset:2048
    buffer_load_dwordx4 v[20:23], v19, s[40:43], s6 offen offset:3072
    s_add_u32 s6, s6, 4096
    buffer_load_dwordx4 v[20:23], v19, s[40:43], s6 offen offset:0
    buffer_load_dwordx4 v[20:23], v19, s[40:43], s6 offen offset:1024
    buffer_load_dwordx4 v[20:23], v19, s[40:43], s6 offen offset:2048
    s_add_u32 s11, s11, 229376
    s_mov_b32 s40, s28
    s_mov_b32 s41, s29
    s_mov_b32 s42, 0x700000
    s_mov_b32 s43, 0x20000
    s_mov_b32 s44, s20
    s_mov_b32 s45, s21
    s_mov_b32 s46, 0x80000
    s_mov_b32 s47, 0x20000
    s_mul_i32 s11, s10, 4096
    s_mul_i32 s7, s2, 16384
    s_add_u32 s11, s11, s7
    s_add_u32 s11, s11, 0
    s_mov_b32 s6, s11
    buffer_load_dwordx4 v[20:23], v19, s[44:47], s6 offen offset:0
    buffer_load_dwordx4 v[20:23], v19, s[44:47], s6 offen offset:1024
    buffer_load_dwordx4 v[20:23], v19, s[44:47], s6 offen offset:2048
    buffer_load_dwordx4 v[20:23], v19, s[44:47], s6 offen offset:3072
    s_add_u32 s6, s6, 4096
    s_add_u32 s11, s11, 0
    s_mul_i32 s11, s10, 1835008
    s_mul_i32 s7, s2, 8192
    s_add_u32 s11, s11, s7
    s_add_u32 s11, s11, 0
    s_mov_b32 s6, s11
    buffer_load_dwordx4 v[20:23], v19, s[40:43], s6 offen offset:0
    buffer_load_dwordx4 v[20:23], v19, s[40:43], s6 offen offset:1024
    buffer_load_dwordx4 v[20:23], v19, s[40:43], s6 offen offset:2048
    buffer_load_dwordx4 v[20:23], v19, s[40:43], s6 offen offset:3072
    s_add_u32 s6, s6, 4096
    buffer_load_dwordx4 v[20:23], v19, s[40:43], s6 offen offset:0
    buffer_load_dwordx4 v[20:23], v19, s[40:43], s6 offen offset:1024
    buffer_load_dwordx4 v[20:23], v19, s[40:43], s6 offen offset:2048
    buffer_load_dwordx4 v[20:23], v19, s[40:43], s6 offen offset:3072
    s_add_u32 s6, s6, 4096
    s_add_u32 s11, s11, 262144
    s_mov_b32 s6, s11
    buffer_load_dwordx4 v[20:23], v19, s[40:43], s6 offen offset:0
    buffer_load_dwordx4 v[20:23], v19, s[40:43], s6 offen offset:1024
    buffer_load_dwordx4 v[20:23], v19, s[40:43], s6 offen offset:2048
    buffer_load_dwordx4 v[20:23], v19, s[40:43], s6 offen offset:3072
    s_add_u32 s6, s6, 4096
    buffer_load_dwordx4 v[20:23], v19, s[40:43], s6 offen offset:0
    buffer_load_dwordx4 v[20:23], v19, s[40:43], s6 offen offset:1024
    buffer_load_dwordx4 v[20:23], v19, s[40:43], s6 offen offset:2048
    buffer_load_dwordx4 v[20:23], v19, s[40:43], s6 offen offset:3072
    s_add_u32 s6, s6, 4096
    s_add_u32 s11, s11, 262144
    s_mov_b32 s6, s11
    buffer_load_dwordx4 v[20:23], v19, s[40:43], s6 offen offset:0
    buffer_load_dwordx4 v[20:23], v19, s[40:43], s6 offen offset:1024
    buffer_load_dwordx4 v[20:23], v19, s[40:43], s6 offen offset:2048
    buffer_load_dwordx4 v[20:23], v19, s[40:43], s6 offen offset:3072
    s_add_u32 s6, s6, 4096
    buffer_load_dwordx4 v[20:23], v19, s[40:43], s6 offen offset:0
    buffer_load_dwordx4 v[20:23], v19, s[40:43], s6 offen offset:1024
    buffer_load_dwordx4 v[20:23], v19, s[40:43], s6 offen offset:2048
    buffer_load_dwordx4 v[20:23], v19, s[40:43], s6 offen offset:3072
    s_add_u32 s6, s6, 4096
    s_add_u32 s11, s11, 262144
    s_mov_b32 s6, s11
    buffer_load_dwordx4 v[20:23], v19, s[40:43], s6 offen offset:0
    buffer_load_dwordx4 v[20:23], v19, s[40:43], s6 offen offset:1024
    buffer_load_dwordx4 v[20:23], v19, s[40:43], s6 offen offset:2048
    buffer_load_dwordx4 v[20:23], v19, s[40:43], s6 offen offset:3072
    s_add_u32 s6, s6, 4096
    buffer_load_dwordx4 v[20:23], v19, s[40:43], s6 offen offset:0
    buffer_load_dwordx4 v[20:23], v19, s[40:43], s6 offen offset:1024
    buffer_load_dwordx4 v[20:23], v19, s[40:43], s6 offen offset:2048
    buffer_load_dwordx4 v[20:23], v19, s[40:43], s6 offen offset:3072
    s_add_u32 s6, s6, 4096
    s_add_u32 s11, s11, 262144
    s_mov_b32 s6, s11
    buffer_load_dwordx4 v[20:23], v19, s[40:43], s6 offen offset:0
    buffer_load_dwordx4 v[20:23], v19, s[40:43], s6 offen offset:1024
    buffer_load_dwordx4 v[20:23], v19, s[40:43], s6 offen offset:2048
    buffer_load_dwordx4 v[20:23], v19, s[40:43], s6 offen offset:3072
    s_add_u32 s6, s6, 4096
    buffer_load_dwordx4 v[20:23], v19, s[40:43], s6 offen offset:0
    buffer_load_dwordx4 v[20:23], v19, s[40:43], s6 offen offset:1024
    buffer_load_dwordx4 v[20:23], v19, s[40:43], s6 offen offset:2048
    buffer_load_dwordx4 v[20:23], v19, s[40:43], s6 offen offset:3072
    s_add_u32 s6, s6, 4096
    s_add_u32 s11, s11, 262144
    s_setprio 3
    s_add_u32 s44, s38, 0x850000
    s_addc_u32 s45, s39, 0
    s_mov_b32 s46, 0x1c0000
    s_mov_b32 s47, 0x20000
L_g2_70:
    s_and_b32 s54, s5, 7
    s_lshl_b32 s55, s4, 2
    s_lshr_b32 s6, s5, 3
    s_add_u32 s55, s55, s6
    v_lshrrev_b32 v7, 3, v0
    s_movk_i32 s6, 4096
    v_mul_u32_u24_e64 v2, s6, v7
    v_bfe_u32 v7, v0, 4, 1
    v_lshlrev_b32 v7, 2, v7
    v_and_b32 v8, 7, v0
    v_xor_b32_e64 v7, v7, v8
    v_lshl_add_u32 v2, v7, 4, v2
    v_lshrrev_b32 v4, 5, v0
    v_lshlrev_b32 v4, 3, v4
    v_bfe_u32 v7, v0, 2, 2
    v_add_u32 v4, v4, v7
    v_lshlrev_b32 v4, 7, v4
    v_bfe_u32 v7, v0, 4, 1
    v_lshl_add_u32 v4, v7, 5, v4
    v_and_b32_e64 v7, 3, v0
    v_lshl_add_u32 v4, v7, 3, v4
    v_bfe_u32 v7, v0, 3, 1
    v_lshl_add_u32 v4, v7, 6, v4
    s_lshr_b32 s6, s10, 1
    s_lshl_b32 s6, s6, 6
    v_xor_b32 v4, s6, v4
    v_add_u32 v4, s50, v4
    v_xor_b32 v5, 64, v4
    s_mov_b32 s40, s28
    s_mov_b32 s41, s29
    s_mov_b32 s42, 0x700000
    s_mov_b32 s43, 0x20000
    s_cmp_lg_u32 s3, 9
    s_cbranch_scc1 L_cp_88
    s_getpc_b64 s[64:65]
L_cph_89:
    s_sub_u32 s64, s64, L_cph_89 - gated_mix__softmax_full_mha__mixer_token_mlp__prompt_kernel
    s_subb_u32 s65, s65, 0
    s_mov_b32 s66, L_end - gated_mix__softmax_full_mha__mixer_token_mlp__prompt_kernel
    s_mov_b32 s67, 0x20000
    s_lshl_b32 s6, s5, 10
    v_lshlrev_b32 v7, 6, v0
    s_mov_b64 exec, 0xffff
    buffer_load_dword v20, v7, s[64:67], s6 offen
    s_mov_b64 exec, -1
L_cp_88:
    s_mul_i32 s6, s10, 1835008
    s_lshl_b32 s7, s2, 10
    s_add_u32 s6, s6, s7
    s_add_u32 s6, s6, 1310720
    v_lshlrev_b32 v7, 4, v0
    buffer_load_dwordx4 v[20:23], v7, s[40:43], s6 offen
    s_add_u32 s6, s6, 262144
    buffer_load_dwordx4 v[20:23], v7, s[40:43], s6 offen
    s_add_u32 s6, s6, 262144
    s_mul_i32 s51, s10, 1835008
    s_lshl_b32 s6, s55, 7
    s_add_u32 s51, s51, s6
    s_add_u32 s52, s51, 32768
    s_mul_i32 s53, s10, 458752
    s_lshl_b32 s6, s54, 11
    s_add_u32 s53, s53, s6
    buffer_load_dwordx4 v[96:99], v2, s[40:43], s51 offen
    s_add_u32 s51, s51, 65536
    buffer_load_dwordx4 v[100:103], v2, s[40:43], s52 offen
    s_add_u32 s52, s52, 65536
    buffer_load_dwordx4 v[104:107], v2, s[40:43], s51 offen
    s_add_u32 s51, s51, 65536
    buffer_load_dwordx4 v[108:111], v2, s[40:43], s52 offen
    s_add_u32 s52, s52, 65536
    buffer_load_dwordx4 v[112:115], v2, s[40:43], s51 offen
    s_add_u32 s51, s51, 65536
    buffer_load_dwordx4 v[116:119], v2, s[40:43], s52 offen
    s_add_u32 s52, s52, 65536
    buffer_load_dwordx4 v[120:123], v2, s[40:43], s51 offen
    s_add_u32 s51, s51, 65536
    buffer_load_dwordx4 v[124:127], v2, s[40:43], s52 offen
    s_add_u32 s52, s52, 65536
    s_lshl_b32 s7, s54, 8
    s_lshl_b32 s6, s4, 14
    s_add_u32 s7, s7, s6
    s_lshr_b32 s6, s10, 1
    s_lshl_b32 s6, s6, 7
    s_add_u32 s7, s7, s6
    s_and_b32 s6, s10, 1
    s_mul_i32 s6, s6, 28
    s_add_u32 s7, s7, s6
    v_lshlrev_b32 v7, 2, v0
    s_movk_i32 s12, 0x7f
    s_mov_b32 s13, 0
    s_mov_b64 exec, s[12:13]
L_gp_90:
    buffer_load_dword v8, v7, s[56:59], s7 offen sc1
    s_waitcnt vmcnt(0)
    v_cmp_eq_u32 vcc, s71, v8
    s_cmp_eq_u64 vcc, s[12:13]
    s_cbranch_scc1 L_gpd_91
    s_sleep 4
    s_sub_u32 s70, s70, 1
    s_cmp_gt_i32 s70, 0
    s_cbranch_scc1 L_gp_90
L_gpd_91:
    s_mov_b64 exec, -1
    s_mov_b32 s64, s30
    s_mov_b32 s65, s31
    s_mov_b32 s66, 0x1000
    s_mov_b32 s67, 0x20000
    s_lshl_b32 s6, s55, 6
    s_lshr_b32 s7, s10, 1
    s_lshl_b32 s7, s7, 5
    s_add_u32 s6, s6, s7
    v_and_b32 v7, 31, v0
    v_add_u32 v7, s6, v7
    v_lshlrev_b32 v8, 2, v7
    v_lshlrev_b32 v7, 1, v7
    buffer_load_dword v15, v8, s[60:63], 0 offen sc1
    buffer_load_ushort v1, v7, s[64:67], 0 offen
    buffer_load_dwordx4 v[128:131], v3, s[44:47], s53 offen sc1
    buffer_load_dwordx4 v[132:135], v6, s[44:47], s53 offen sc1
    s_add_u32 s53, s53, 16384
    buffer_load_dwordx4 v[136:139], v3, s[44:47], s53 offen sc1
    buffer_load_dwordx4 v[140:143], v6, s[44:47], s53 offen sc1
    s_add_u32 s53, s53, 16384
    buffer_load_dwordx4 v[144:147], v3, s[44:47], s53 offen sc1
    buffer_load_dwordx4 v[148:151], v6, s[44:47], s53 offen sc1
    s_add_u32 s53, s53, 16384
    buffer_load_dwordx4 v[152:155], v3, s[44:47], s53 offen sc1
    buffer_load_dwordx4 v[156:159], v6, s[44:47], s53 offen sc1
    s_add_u32 s53, s53, 16384
    buffer_load_dwordx4 v[160:163], v3, s[44:47], s53 offen sc1
    buffer_load_dwordx4 v[164:167], v6, s[44:47], s53 offen sc1
    s_add_u32 s53, s53, 16384
    v_lshlrev_b32 v7, 4, v0
    v_add_u32 v8, s50, v7
    s_xor_b32 s6, s10, 1
    s_mul_i32 s6, s6, 6144
    s_add_u32 s6, s6, 131072
    v_add_u32 v9, s6, v7
    s_xor_b32 s6, s10, 2
    s_mul_i32 s6, s6, 6144
    s_add_u32 s6, s6, 133120
    v_add_u32 v10, s6, v7
    s_xor_b32 s6, s10, 3
    s_mul_i32 s6, s6, 6144
    s_add_u32 s6, s6, 135168
    v_add_u32_e64 v11, s6, v7
    s_setprio 1
    s_bitcmp1_b32 s4, 0
    s_cbranch_scc0 L_pp_92
    s_setprio 0
L_pp_92:
    s_waitcnt vmcnt(16)
    ds_write_b128 v14, v[96:99] offset:0
    ds_write_b128 v14, v[100:103] offset:1024
    ds_write_b128 v14, v[104:107] offset:2048
    ds_write_b128 v14, v[108:111] offset:3072
    buffer_load_dwordx4 v[96:99], v2, s[40:43], s51 offen
    s_add_u32 s51, s51, 65536
    buffer_load_dwordx4 v[100:103], v2, s[40:43], s52 offen
    s_add_u32 s52, s52, 65536
    buffer_load_dwordx4 v[104:107], v2, s[40:43], s51 offen
    s_add_u32 s51, s51, 65536
    buffer_load_dwordx4 v[108:111], v2, s[40:43], s52 offen
    s_add_u32 s52, s52, 65536
    s_waitcnt lgkmcnt(0)
    ds_read_b64_tr_b16 v[80:81], v4 offset:0
    ds_read_b64_tr_b16 v[82:83], v4 offset:512
    ds_read_b64_tr_b16 v[84:85], v5 offset:0
    ds_read_b64_tr_b16 v[86:87], v5 offset:512
    s_waitcnt lgkmcnt(0)
    ds_read_b64_tr_b16 v[88:89], v4 offset:2048
    ds_read_b64_tr_b16 v[90:91], v4 offset:2560
    ds_read_b64_tr_b16 v[92:93], v5 offset:2048
    ds_read_b64_tr_b16 v[94:95], v5 offset:2560
    s_waitcnt vmcnt(12)
    ds_write_b128 v14, v[112:115] offset:0
    ds_write_b128 v14, v[116:119] offset:1024
    v_mfma_f32_32x32x16_bf16 v[16:31], v[128:131], v[80:83], 0
    buffer_load_dwordx4 v[112:115], v2, s[40:43], s51 offen
    s_add_u32 s51, s51, 65536
    v_mfma_f32_32x32x16_bf16 v[32:47], v[132:135], v[80:83], 0
    buffer_load_dwordx4 v[116:119], v2, s[40:43], s52 offen
    s_add_u32 s52, s52, 65536
    v_mfma_f32_32x32x16_bf16 v[48:63], v[128:131], v[84:87], 0
    v_mfma_f32_32x32x16_bf16 v[64:79], v[132:135], v[84:87], 0
    s_waitcnt lgkmcnt(0)
    ds_read_b64_tr_b16 v[80:81], v4 offset:0
    ds_read_b64_tr_b16 v[82:83], v4 offset:512
    ds_read_b64_tr_b16 v[84:85], v5 offset:0
    ds_read_b64_tr_b16 v[86:87], v5 offset:512
    s_waitcnt vmcnt(12)
    ds_write_b128 v14, v[120:123] offset:2048
    ds_write_b128 v14, v[124:127] offset:3072
    v_mfma_f32_32x32x16_bf16 v[16:31], v[136:139], v[88:91], v[16:31]
    buffer_load_dwordx4 v[120:123], v2, s[40:43], s51 offen
    s_add_u32 s51, s51, 65536
    v_mfma_f32_32x32x16_bf16 v[32:47], v[140:143], v[88:91], v[32:47]
    buffer_load_dwordx4 v[124:127], v2, s[40:43], s52 offen
    s_add_u32 s52, s52, 65536
    v_mfma_f32_32x32x16_bf16 v[48:63], v[136:139], v[92:95], v[48:63]
    buffer_load_dwordx4 v[128:131], v3, s[44:47], s53 offen sc1
    v_mfma_f32_32x32x16_bf16 v[64:79], v[140:143], v[92:95], v[64:79]
    buffer_load_dwordx4 v[132:135], v6, s[44:47], s53 offen sc1
    s_add_u32 s53, s53, 16384
    s_waitcnt lgkmcnt(0)
    ds_read_b64_tr_b16 v[88:89], v4 offset:2048
    ds_read_b64_tr_b16 v[90:91], v4 offset:2560
    ds_read_b64_tr_b16 v[92:93], v5 offset:2048
    ds_read_b64_tr_b16 v[94:95], v5 offset:2560
    s_waitcnt vmcnt(8)
    ds_write_b128 v14, v[96:99] offset:0
    ds_write_b128 v14, v[100:103] offset:1024
    v_mfma_f32_32x32x16_bf16 v[16:31], v[144:147], v[80:83], v[16:31]
    buffer_load_dwordx4 v[96:99], v2, s[40:43], s51 offen
    s_add_u32 s51, s51, 65536
    v_mfma_f32_32x32x16_bf16 v[32:47], v[148:151], v[80:83], v[32:47]
    buffer_load_dwordx4 v[100:103], v2, s[40:43], s52 offen
    s_add_u32 s52, s52, 65536
    v_mfma_f32_32x32x16_bf16 v[48:63], v[144:147], v[84:87], v[48:63]
    buffer_load_dwordx4 v[136:139], v3, s[44:47], s53 offen sc1
    v_mfma_f32_32x32x16_bf16 v[64:79], v[148:151], v[84:87], v[64:79]
    buffer_load_dwordx4 v[140:143], v6, s[44:47], s53 offen sc1
    s_add_u32 s53, s53, 16384
    s_waitcnt lgkmcnt(0)
    ds_read_b64_tr_b16 v[80:81], v4 offset:0
    ds_read_b64_tr_b16 v[82:83], v4 offset:512
    ds_read_b64_tr_b16 v[84:85], v5 offset:0
    ds_read_b64_tr_b16 v[86:87], v5 offset:512
    s_waitcnt vmcnt(10)
    ds_write_b128 v14, v[104:107] offset:2048
    ds_write_b128 v14, v[108:111] offset:3072
    v_mfma_f32_32x32x16_bf16 v[16:31], v[152:155], v[88:91], v[16:31]
    buffer_load_dwordx4 v[104:107], v2, s[40:43], s51 offen
    s_add_u32 s51, s51, 65536
    v_mfma_f32_32x32x16_bf16 v[32:47], v[156:159], v[88:91], v[32:47]
    buffer_load_dwordx4 v[108:111], v2, s[40:43], s52 offen
    s_add_u32 s52, s52, 65536
    v_mfma_f32_32x32x16_bf16 v[48:63], v[152:155], v[92:95], v[48:63]
    buffer_load_dwordx4 v[144:147], v3, s[44:47], s53 offen sc1
    v_mfma_f32_32x32x16_bf16 v[64:79], v[156:159], v[92:95], v[64:79]
    buffer_load_dwordx4 v[148:151], v6, s[44:47], s53 offen sc1
    s_add_u32 s53, s53, 16384
    s_waitcnt lgkmcnt(0)
    ds_read_b64_tr_b16 v[88:89], v4 offset:2048
    ds_read_b64_tr_b16 v[90:91], v4 offset:2560
    ds_read_b64_tr_b16 v[92:93], v5 offset:2048
    ds_read_b64_tr_b16 v[94:95], v5 offset:2560
    s_waitcnt vmcnt(12)
    ds_write_b128 v14, v[112:115] offset:0
    ds_write_b128 v14, v[116:119] offset:1024
    v_mfma_f32_32x32x16_bf16 v[16:31], v[160:163], v[80:83], v[16:31]
    buffer_load_dwordx4 v[112:115], v2, s[40:43], s51 offen
    s_add_u32 s51, s51, 65536
    v_mfma_f32_32x32x16_bf16 v[32:47], v[164:167], v[80:83], v[32:47]
    buffer_load_dwordx4 v[116:119], v2, s[40:43], s52 offen
    s_add_u32 s52, s52, 65536
    v_mfma_f32_32x32x16_bf16 v[48:63], v[160:163], v[84:87], v[48:63]
    buffer_load_dwordx4 v[152:155], v3, s[44:47], s53 offen sc1
    v_mfma_f32_32x32x16_bf16 v[64:79], v[164:167], v[84:87], v[64:79]
    buffer_load_dwordx4 v[156:159], v6, s[44:47], s53 offen sc1
    s_add_u32 s53, s53, 16384
    s_waitcnt lgkmcnt(0)
    ds_read_b64_tr_b16 v[80:81], v4 offset:0
    ds_read_b64_tr_b16 v[82:83], v4 offset:512
    ds_read_b64_tr_b16 v[84:85], v5 offset:0
    ds_read_b64_tr_b16 v[86:87], v5 offset:512
    s_waitcnt vmcnt(12)
    ds_write_b128 v14, v[120:123] offset:2048
    ds_write_b128 v14, v[124:127] offset:3072
    v_mfma_f32_32x32x16_bf16 v[16:31], v[128:131], v[88:91], v[16:31]
    buffer_load_dwordx4 v[120:123], v2, s[40:43], s51 offen
    s_add_u32 s51, s51, 65536
    v_mfma_f32_32x32x16_bf16 v[32:47], v[132:135], v[88:91], v[32:47]
    buffer_load_dwordx4 v[124:127], v2, s[40:43], s52 offen
    s_add_u32 s52, s52, 65536
    v_mfma_f32_32x32x16_bf16 v[48:63], v[128:131], v[92:95], v[48:63]
    buffer_load_dwordx4 v[160:163], v3, s[44:47], s53 offen sc1
    v_mfma_f32_32x32x16_bf16 v[64:79], v[132:135], v[92:95], v[64:79]
    buffer_load_dwordx4 v[164:167], v6, s[44:47], s53 offen sc1
    s_add_u32 s53, s53, 16384
    s_waitcnt lgkmcnt(0)
    ds_read_b64_tr_b16 v[88:89], v4 offset:2048
    ds_read_b64_tr_b16 v[90:91], v4 offset:2560
    ds_read_b64_tr_b16 v[92:93], v5 offset:2048
    ds_read_b64_tr_b16 v[94:95], v5 offset:2560
    s_waitcnt vmcnt(12)
    ds_write_b128 v14, v[96:99] offset:0
    ds_write_b128 v14, v[100:103] offset:1024
    v_mfma_f32_32x32x16_bf16 v[16:31], v[136:139], v[80:83], v[16:31]
    buffer_load_dwordx4 v[96:99], v2, s[40:43], s51 offen
    s_add_u32 s51, s51, 65536
    v_mfma_f32_32x32x16_bf16 v[32:47], v[140:143], v[80:83], v[32:47]
    buffer_load_dwordx4 v[100:103], v2, s[40:43], s52 offen
    s_add_u32 s52, s52, 65536
    v_mfma_f32_32x32x16_bf16 v[48:63], v[136:139], v[84:87], v[48:63]
    buffer_load_dwordx4 v[128:131], v3, s[44:47], s53 offen sc1
    v_mfma_f32_32x32x16_bf16 v[64:79], v[140:143], v[84:87], v[64:79]
    buffer_load_dwordx4 v[132:135], v6, s[44:47], s53 offen sc1
    s_add_u32 s53, s53, 16384
    s_waitcnt lgkmcnt(0)
    ds_read_b64_tr_b16 v[80:81], v4 offset:0
    ds_read_b64_tr_b16 v[82:83], v4 offset:512
    ds_read_b64_tr_b16 v[84:85], v5 offset:0
    ds_read_b64_tr_b16 v[86:87], v5 offset:512
    s_waitcnt vmcnt(12)
    ds_write_b128 v14, v[104:107] offset:2048
    ds_write_b128 v14, v[108:111] offset:3072
    v_mfma_f32_32x32x16_bf16 v[16:31], v[144:147], v[88:91], v[16:31]
    buffer_load_dwordx4 v[104:107], v2, s[40:43], s51 offen
    s_add_u32 s51, s51, 65536
    v_mfma_f32_32x32x16_bf16 v[32:47], v[148:151], v[88:91], v[32:47]
    buffer_load_dwordx4 v[108:111], v2, s[40:43], s52 offen
    s_add_u32 s52, s52, 65536
    v_mfma_f32_32x32x16_bf16 v[48:63], v[144:147], v[92:95], v[48:63]
    buffer_load_dwordx4 v[136:139], v3, s[44:47], s53 offen sc1
    v_mfma_f32_32x32x16_bf16 v[64:79], v[148:151], v[92:95], v[64:79]
    buffer_load_dwordx4 v[140:143], v6, s[44:47], s53 offen sc1
    s_add_u32 s53, s53, 16384
    s_waitcnt lgkmcnt(0)
    ds_read_b64_tr_b16 v[88:89], v4 offset:2048
    ds_read_b64_tr_b16 v[90:91], v4 offset:2560
    ds_read_b64_tr_b16 v[92:93], v5 offset:2048
    ds_read_b64_tr_b16 v[94:95], v5 offset:2560
    s_waitcnt vmcnt(12)
    ds_write_b128 v14, v[112:115] offset:0
    ds_write_b128 v14, v[116:119] offset:1024
    v_mfma_f32_32x32x16_bf16 v[16:31], v[152:155], v[80:83], v[16:31]
    buffer_load_dwordx4 v[112:115], v2, s[40:43], s51 offen
    s_add_u32 s51, s51, 65536
    v_mfma_f32_32x32x16_bf16 v[32:47], v[156:159], v[80:83], v[32:47]
    buffer_load_dwordx4 v[116:119], v2, s[40:43], s52 offen
    s_add_u32 s52, s52, 65536
    v_mfma_f32_32x32x16_bf16 v[48:63], v[152:155], v[84:87], v[48:63]
    buffer_load_dwordx4 v[144:147], v3, s[44:47], s53 offen sc1
    v_mfma_f32_32x32x16_bf16 v[64:79], v[156:159], v[84:87], v[64:79]
    buffer_load_dwordx4 v[148:151], v6, s[44:47], s53 offen sc1
    s_add_u32 s53, s53, 16384
    s_waitcnt lgkmcnt(0)
    ds_read_b64_tr_b16 v[80:81], v4 offset:0
    ds_read_b64_tr_b16 v[82:83], v4 offset:512
    ds_read_b64_tr_b16 v[84:85], v5 offset:0
    ds_read_b64_tr_b16 v[86:87], v5 offset:512
    s_waitcnt vmcnt(12)
    ds_write_b128 v14, v[120:123] offset:2048
    ds_write_b128 v14, v[124:127] offset:3072
    v_mfma_f32_32x32x16_bf16 v[16:31], v[160:163], v[88:91], v[16:31]
    buffer_load_dwordx4 v[120:123], v2, s[40:43], s51 offen
    s_add_u32 s51, s51, 65536
    v_mfma_f32_32x32x16_bf16 v[32:47], v[164:167], v[88:91], v[32:47]
    buffer_load_dwordx4 v[124:127], v2, s[40:43], s52 offen
    s_add_u32 s52, s52, 65536
    v_mfma_f32_32x32x16_bf16 v[48:63], v[160:163], v[92:95], v[48:63]
    buffer_load_dwordx4 v[152:155], v3, s[44:47], s53 offen sc1
    v_mfma_f32_32x32x16_bf16 v[64:79], v[164:167], v[92:95], v[64:79]
    buffer_load_dwordx4 v[156:159], v6, s[44:47], s53 offen sc1
    s_add_u32 s53, s53, 16384
    s_waitcnt lgkmcnt(0)
    ds_read_b64_tr_b16 v[88:89], v4 offset:2048
    ds_read_b64_tr_b16 v[90:91], v4 offset:2560
    ds_read_b64_tr_b16 v[92:93], v5 offset:2048
    ds_read_b64_tr_b16 v[94:95], v5 offset:2560
    s_waitcnt vmcnt(12)
    ds_write_b128 v14, v[96:99] offset:0
    ds_write_b128 v14, v[100:103] offset:1024
    v_mfma_f32_32x32x16_bf16 v[16:31], v[128:131], v[80:83], v[16:31]
    buffer_load_dwordx4 v[96:99], v2, s[40:43], s51 offen
    s_add_u32 s51, s51, 65536
    v_mfma_f32_32x32x16_bf16 v[32:47], v[132:135], v[80:83], v[32:47]
    buffer_load_dwordx4 v[100:103], v2, s[40:43], s52 offen
    s_add_u32 s52, s52, 65536
    v_mfma_f32_32x32x16_bf16 v[48:63], v[128:131], v[84:87], v[48:63]
    buffer_load_dwordx4 v[160:163], v3, s[44:47], s53 offen sc1
    v_mfma_f32_32x32x16_bf16 v[64:79], v[132:135], v[84:87], v[64:79]
    buffer_load_dwordx4 v[164:167], v6, s[44:47], s53 offen sc1
    s_add_u32 s53, s53, 16384
    s_waitcnt lgkmcnt(0)
    ds_read_b64_tr_b16 v[80:81], v4 offset:0
    ds_read_b64_tr_b16 v[82:83], v4 offset:512
    ds_read_b64_tr_b16 v[84:85], v5 offset:0
    ds_read_b64_tr_b16 v[86:87], v5 offset:512
    s_waitcnt vmcnt(12)
    ds_write_b128 v14, v[104:107] offset:2048
    ds_write_b128 v14, v[108:111] offset:3072
    v_mfma_f32_32x32x16_bf16 v[16:31], v[136:139], v[88:91], v[16:31]
    buffer_load_dwordx4 v[104:107], v2, s[40:43], s51 offen
    s_add_u32 s51, s51, 65536
    v_mfma_f32_32x32x16_bf16 v[32:47], v[140:143], v[88:91], v[32:47]
    buffer_load_dwordx4 v[108:111], v2, s[40:43], s52 offen
    s_add_u32 s52, s52, 65536
    v_mfma_f32_32x32x16_bf16 v[48:63], v[136:139], v[92:95], v[48:63]
    buffer_load_dwordx4 v[128:131], v3, s[44:47], s53 offen sc1
    v_mfma_f32_32x32x16_bf16 v[64:79], v[140:143], v[92:95], v[64:79]
    buffer_load_dwordx4 v[132:135], v6, s[44:47], s53 offen sc1
    s_add_u32 s53, s53, 16384
    s_setprio 1
    s_waitcnt lgkmcnt(0)
    ds_read_b64_tr_b16 v[88:89], v4 offset:2048
    ds_read_b64_tr_b16 v[90:91], v4 offset:2560
    ds_read_b64_tr_b16 v[92:93], v5 offset:2048
    ds_read_b64_tr_b16 v[94:95], v5 offset:2560
    s_waitcnt vmcnt(12)
    ds_write_b128 v14, v[112:115] offset:0
    ds_write_b128 v14, v[116:119] offset:1024
    s_nop 0
    v_mfma_f32_32x32x16_bf16 v[16:31], v[144:147], v[80:83], v[16:31]
    buffer_load_dwordx4 v[112:115], v2, s[40:43], s51 offen
    s_add_u32 s51, s51, 65536
    v_mfma_f32_32x32x16_bf16 v[32:47], v[148:151], v[80:83], v[32:47]
    buffer_load_dwordx4 v[116:119], v2, s[40:43], s52 offen
    s_add_u32 s52, s52, 65536
    v_mfma_f32_32x32x16_bf16 v[48:63], v[144:147], v[84:87], v[48:63]
    buffer_load_dwordx4 v[136:139], v3, s[44:47], s53 offen sc1
    v_mfma_f32_32x32x16_bf16 v[64:79], v[148:151], v[84:87], v[64:79]
    buffer_load_dwordx4 v[140:143], v6, s[44:47], s53 offen sc1
    s_add_u32 s53, s53, 16384
    s_waitcnt lgkmcnt(0)
    ds_read_b64_tr_b16 v[80:81], v4 offset:0
    ds_read_b64_tr_b16 v[82:83], v4 offset:512
    ds_read_b64_tr_b16 v[84:85], v5 offset:0
    ds_read_b64_tr_b16 v[86:87], v5 offset:512
    s_waitcnt vmcnt(12)
    ds_write_b128 v14, v[120:123] offset:2048
    ds_write_b128 v14, v[124:127] offset:3072
    v_mfma_f32_32x32x16_bf16 v[16:31], v[152:155], v[88:91], v[16:31]
    buffer_load_dwordx4 v[120:123], v2, s[40:43], s51 offen
    s_add_u32 s51, s51, 65536
    v_mfma_f32_32x32x16_bf16 v[32:47], v[156:159], v[88:91], v[32:47]
    buffer_load_dwordx4 v[124:127], v2, s[40:43], s52 offen
    s_add_u32 s52, s52, 65536
    v_mfma_f32_32x32x16_bf16 v[48:63], v[152:155], v[92:95], v[48:63]
    buffer_load_dwordx4 v[144:147], v3, s[44:47], s53 offen sc1
    v_mfma_f32_32x32x16_bf16 v[64:79], v[156:159], v[92:95], v[64:79]
    buffer_load_dwordx4 v[148:151], v6, s[44:47], s53 offen sc1
    s_add_u32 s53, s53, 16384
    s_waitcnt lgkmcnt(0)
    ds_read_b64_tr_b16 v[88:89], v4 offset:2048
    ds_read_b64_tr_b16 v[90:91], v4 offset:2560
    ds_read_b64_tr_b16 v[92:93], v5 offset:2048
    ds_read_b64_tr_b16 v[94:95], v5 offset:2560
    s_waitcnt vmcnt(12)
    ds_write_b128 v14, v[96:99] offset:0
    ds_write_b128 v14, v[100:103] offset:1024
    v_mfma_f32_32x32x16_bf16 v[16:31], v[160:163], v[80:83], v[16:31]
    buffer_load_dwordx4 v[96:99], v2, s[40:43], s51 offen
    s_add_u32 s51, s51, 65536
    v_mfma_f32_32x32x16_bf16 v[32:47], v[164:167], v[80:83], v[32:47]
    buffer_load_dwordx4 v[100:103], v2, s[40:43], s52 offen
    s_add_u32 s52, s52, 65536
    v_mfma_f32_32x32x16_bf16 v[48:63], v[160:163], v[84:87], v[48:63]
    buffer_load_dwordx4 v[152:155], v3, s[44:47], s53 offen sc1
    v_mfma_f32_32x32x16_bf16 v[64:79], v[164:167], v[84:87], v[64:79]
    buffer_load_dwordx4 v[156:159], v6, s[44:47], s53 offen sc1
    s_add_u32 s53, s53, 16384
    s_waitcnt lgkmcnt(0)
    ds_read_b64_tr_b16 v[80:81], v4 offset:0
    ds_read_b64_tr_b16 v[82:83], v4 offset:512
    ds_read_b64_tr_b16 v[84:85], v5 offset:0
    ds_read_b64_tr_b16 v[86:87], v5 offset:512
    s_waitcnt vmcnt(12)
    ds_write_b128 v14, v[104:107] offset:2048
    ds_write_b128 v14, v[108:111] offset:3072
    v_mfma_f32_32x32x16_bf16 v[16:31], v[128:131], v[88:91], v[16:31]
    buffer_load_dwordx4 v[104:107], v2, s[40:43], s51 offen
    s_add_u32 s51, s51, 65536
    v_mfma_f32_32x32x16_bf16 v[32:47], v[132:135], v[88:91], v[32:47]
    buffer_load_dwordx4 v[108:111], v2, s[40:43], s52 offen
    s_add_u32 s52, s52, 65536
    v_mfma_f32_32x32x16_bf16 v[48:63], v[128:131], v[92:95], v[48:63]
    buffer_load_dwordx4 v[160:163], v3, s[44:47], s53 offen sc1
    v_mfma_f32_32x32x16_bf16 v[64:79], v[132:135], v[92:95], v[64:79]
    buffer_load_dwordx4 v[164:167], v6, s[44:47], s53 offen sc1
    s_add_u32 s53, s53, 16384
    s_waitcnt lgkmcnt(0)
    ds_read_b64_tr_b16 v[88:89], v4 offset:2048
    ds_read_b64_tr_b16 v[90:91], v4 offset:2560
    ds_read_b64_tr_b16 v[92:93], v5 offset:2048
    ds_read_b64_tr_b16 v[94:95], v5 offset:2560
    s_waitcnt vmcnt(12)
    ds_write_b128 v14, v[112:115] offset:0
    ds_write_b128 v14, v[116:119] offset:1024
    v_mfma_f32_32x32x16_bf16 v[16:31], v[136:139], v[80:83], v[16:31]
    buffer_load_dwordx4 v[112:115], v2, s[40:43], s51 offen
    s_add_u32 s51, s51, 65536
    v_mfma_f32_32x32x16_bf16 v[32:47], v[140:143], v[80:83], v[32:47]
    buffer_load_dwordx4 v[116:119], v2, s[40:43], s52 offen
    s_add_u32 s52, s52, 65536
    v_mfma_f32_32x32x16_bf16 v[48:63], v[136:139], v[84:87], v[48:63]
    buffer_load_dwordx4 v[128:131], v3, s[44:47], s53 offen sc1
    v_mfma_f32_32x32x16_bf16 v[64:79], v[140:143], v[84:87], v[64:79]
    buffer_load_dwordx4 v[132:135], v6, s[44:47], s53 offen sc1
    s_add_u32 s53, s53, 16384
    s_waitcnt lgkmcnt(0)
    ds_read_b64_tr_b16 v[80:81], v4 offset:0
    ds_read_b64_tr_b16 v[82:83], v4 offset:512
    ds_read_b64_tr_b16 v[84:85], v5 offset:0
    ds_read_b64_tr_b16 v[86:87], v5 offset:512
    s_waitcnt vmcnt(12)
    ds_write_b128 v14, v[120:123] offset:2048
    ds_write_b128 v14, v[124:127] offset:3072
    v_mfma_f32_32x32x16_bf16 v[16:31], v[144:147], v[88:91], v[16:31]
    buffer_load_dwordx4 v[120:123], v2, s[40:43], s51 offen
    s_add_u32 s51, s51, 65536
    v_mfma_f32_32x32x16_bf16 v[32:47], v[148:151], v[88:91], v[32:47]
    buffer_load_dwordx4 v[124:127], v2, s[40:43], s52 offen
    s_add_u32 s52, s52, 65536
    v_mfma_f32_32x32x16_bf16 v[48:63], v[144:147], v[92:95], v[48:63]
    buffer_load_dwordx4 v[136:139], v3, s[44:47], s53 offen sc1
    v_mfma_f32_32x32x16_bf16 v[64:79], v[148:151], v[92:95], v[64:79]
    buffer_load_dwordx4 v[140:143], v6, s[44:47], s53 offen sc1
    s_add_u32 s53, s53, 16384
    s_waitcnt lgkmcnt(0)
    ds_read_b64_tr_b16 v[88:89], v4 offset:2048
    ds_read_b64_tr_b16 v[90:91], v4 offset:2560
    ds_read_b64_tr_b16 v[92:93], v5 offset:2048
    ds_read_b64_tr_b16 v[94:95], v5 offset:2560
    s_waitcnt vmcnt(12)
    ds_write_b128 v14, v[96:99] offset:0
    ds_write_b128 v14, v[100:103] offset:1024
    v_mfma_f32_32x32x16_bf16 v[16:31], v[152:155], v[80:83], v[16:31]
    buffer_load_dwordx4 v[96:99], v2, s[40:43], s51 offen
    s_add_u32 s51, s51, 65536
    v_mfma_f32_32x32x16_bf16 v[32:47], v[156:159], v[80:83], v[32:47]
    buffer_load_dwordx4 v[100:103], v2, s[40:43], s52 offen
    s_add_u32 s52, s52, 65536
    v_mfma_f32_32x32x16_bf16 v[48:63], v[152:155], v[84:87], v[48:63]
    buffer_load_dwordx4 v[144:147], v3, s[44:47], s53 offen sc1
    v_mfma_f32_32x32x16_bf16 v[64:79], v[156:159], v[84:87], v[64:79]
    buffer_load_dwordx4 v[148:151], v6, s[44:47], s53 offen sc1
    s_add_u32 s53, s53, 16384
    s_waitcnt lgkmcnt(0)
    ds_read_b64_tr_b16 v[80:81], v4 offset:0
    ds_read_b64_tr_b16 v[82:83], v4 offset:512
    ds_read_b64_tr_b16 v[84:85], v5 offset:0
    ds_read_b64_tr_b16 v[86:87], v5 offset:512
    s_waitcnt vmcnt(12)
    ds_write_b128 v14, v[104:107] offset:2048
    ds_write_b128 v14, v[108:111] offset:3072
    v_mfma_f32_32x32x16_bf16 v[16:31], v[160:163], v[88:91], v[16:31]
    buffer_load_dwordx4 v[104:107], v2, s[40:43], s51 offen
    s_add_u32 s51, s51, 65536
    v_mfma_f32_32x32x16_bf16 v[32:47], v[164:167], v[88:91], v[32:47]
    buffer_load_dwordx4 v[108:111], v2, s[40:43], s52 offen
    s_add_u32 s52, s52, 65536
    v_mfma_f32_32x32x16_bf16 v[48:63], v[160:163], v[92:95], v[48:63]
    buffer_load_dwordx4 v[152:155], v3, s[44:47], s53 offen sc1
    v_mfma_f32_32x32x16_bf16 v[64:79], v[164:167], v[92:95], v[64:79]
    buffer_load_dwordx4 v[156:159], v6, s[44:47], s53 offen sc1
    s_add_u32 s53, s53, 16384
    s_waitcnt lgkmcnt(0)
    ds_read_b64_tr_b16 v[88:89], v4 offset:2048
    ds_read_b64_tr_b16 v[90:91], v4 offset:2560
    ds_read_b64_tr_b16 v[92:93], v5 offset:2048
    ds_read_b64_tr_b16 v[94:95], v5 offset:2560
    s_waitcnt vmcnt(12)
    ds_write_b128 v14, v[112:115] offset:0
    ds_write_b128 v14, v[116:119] offset:1024
    v_mfma_f32_32x32x16_bf16 v[16:31], v[128:131], v[80:83], v[16:31]
    buffer_load_dwordx4 v[112:115], v2, s[40:43], s51 offen
    s_add_u32 s51, s51, 65536
    v_mfma_f32_32x32x16_bf16 v[32:47], v[132:135], v[80:83], v[32:47]
    buffer_load_dwordx4 v[116:119], v2, s[40:43], s52 offen
    s_add_u32 s52, s52, 65536
    v_mfma_f32_32x32x16_bf16 v[48:63], v[128:131], v[84:87], v[48:63]
    buffer_load_dwordx4 v[160:163], v3, s[44:47], s53 offen sc1
    v_mfma_f32_32x32x16_bf16 v[64:79], v[132:135], v[84:87], v[64:79]
    buffer_load_dwordx4 v[164:167], v6, s[44:47], s53 offen sc1
    s_add_u32 s53, s53, 16384
    s_waitcnt lgkmcnt(0)
    ds_read_b64_tr_b16 v[80:81], v4 offset:0
    ds_read_b64_tr_b16 v[82:83], v4 offset:512
    ds_read_b64_tr_b16 v[84:85], v5 offset:0
    ds_read_b64_tr_b16 v[86:87], v5 offset:512
    s_waitcnt vmcnt(12)
    ds_write_b128 v14, v[120:123] offset:2048
    ds_write_b128 v14, v[124:127] offset:3072
    v_mfma_f32_32x32x16_bf16 v[16:31], v[136:139], v[88:91], v[16:31]
    buffer_load_dwordx4 v[120:123], v2, s[40:43], s51 offen
    s_add_u32 s51, s51, 65536
    v_mfma_f32_32x32x16_bf16 v[32:47], v[140:143], v[88:91], v[32:47]
    buffer_load_dwordx4 v[124:127], v2, s[40:43], s52 offen
    s_add_u32 s52, s52, 65536
    v_mfma_f32_32x32x16_bf16 v[48:63], v[136:139], v[92:95], v[48:63]
    buffer_load_dwordx4 v[128:131], v3, s[44:47], s53 offen sc1
    v_mfma_f32_32x32x16_bf16 v[64:79], v[140:143], v[92:95], v[64:79]
    buffer_load_dwordx4 v[132:135], v6, s[44:47], s53 offen sc1
    s_add_u32 s53, s53, 16384
    s_waitcnt lgkmcnt(0)
    ds_read_b64_tr_b16 v[88:89], v4 offset:2048
    ds_read_b64_tr_b16 v[90:91], v4 offset:2560
    ds_read_b64_tr_b16 v[92:93], v5 offset:2048
    ds_read_b64_tr_b16 v[94:95], v5 offset:2560
    s_waitcnt vmcnt(12)
    ds_write_b128 v14, v[96:99] offset:0
    ds_write_b128 v14, v[100:103] offset:1024
    v_mfma_f32_32x32x16_bf16 v[16:31], v[144:147], v[80:83], v[16:31]
    v_mfma_f32_32x32x16_bf16 v[32:47], v[148:151], v[80:83], v[32:47]
    v_mfma_f32_32x32x16_bf16 v[48:63], v[144:147], v[84:87], v[48:63]
    buffer_load_dwordx4 v[136:139], v3, s[44:47], s53 offen sc1
    v_mfma_f32_32x32x16_bf16 v[64:79], v[148:151], v[84:87], v[64:79]
    buffer_load_dwordx4 v[140:143], v6, s[44:47], s53 offen sc1
    s_add_u32 s53, s53, 16384
    s_waitcnt lgkmcnt(0)
    ds_read_b64_tr_b16 v[80:81], v4 offset:0
    ds_read_b64_tr_b16 v[82:83], v4 offset:512
    ds_read_b64_tr_b16 v[84:85], v5 offset:0
    ds_read_b64_tr_b16 v[86:87], v5 offset:512
    s_waitcnt vmcnt(10)
    ds_write_b128 v14, v[104:107] offset:2048
    ds_write_b128 v14, v[108:111] offset:3072
    v_mfma_f32_32x32x16_bf16 v[16:31], v[152:155], v[88:91], v[16:31]
    v_mfma_f32_32x32x16_bf16 v[32:47], v[156:159], v[88:91], v[32:47]
    v_mfma_f32_32x32x16_bf16 v[48:63], v[152:155], v[92:95], v[48:63]
    buffer_load_dwordx4 v[144:147], v3, s[44:47], s53 offen sc1
    v_mfma_f32_32x32x16_bf16 v[64:79], v[156:159], v[92:95], v[64:79]
    buffer_load_dwordx4 v[148:151], v6, s[44:47], s53 offen sc1
    s_add_u32 s53, s53, 16384
    s_waitcnt lgkmcnt(0)
    ds_read_b64_tr_b16 v[88:89], v4 offset:2048
    ds_read_b64_tr_b16 v[90:91], v4 offset:2560
    ds_read_b64_tr_b16 v[92:93], v5 offset:2048
    ds_read_b64_tr_b16 v[94:95], v5 offset:2560
    s_waitcnt vmcnt(8)
    ds_write_b128 v14, v[112:115] offset:0
    ds_write_b128 v14, v[116:119] offset:1024
    v_mfma_f32_32x32x16_bf16 v[16:31], v[160:163], v[80:83], v[16:31]
    v_mfma_f32_32x32x16_bf16 v[32:47], v[164:167], v[80:83], v[32:47]
    v_mfma_f32_32x32x16_bf16 v[48:63], v[160:163], v[84:87], v[48:63]
    v_mfma_f32_32x32x16_bf16 v[64:79], v[164:167], v[84:87], v[64:79]
    s_waitcnt lgkmcnt(0)
    ds_read_b64_tr_b16 v[80:81], v4 offset:0
    ds_read_b64_tr_b16 v[82:83], v4 offset:512
    ds_read_b64_tr_b16 v[84:85], v5 offset:0
    ds_read_b64_tr_b16 v[86:87], v5 offset:512
    s_waitcnt vmcnt(4)
    ds_write_b128 v14, v[120:123] offset:2048
    ds_write_b128 v14, v[124:127] offset:3072
    v_mfma_f32_32x32x16_bf16 v[16:31], v[128:131], v[88:91], v[16:31]
    v_mfma_f32_32x32x16_bf16 v[32:47], v[132:135], v[88:91], v[32:47]
    v_mfma_f32_32x32x16_bf16 v[48:63], v[128:131], v[92:95], v[48:63]
    v_mfma_f32_32x32x16_bf16 v[64:79], v[132:135], v[92:95], v[64:79]
    s_waitcnt lgkmcnt(0)
    ds_read_b64_tr_b16 v[88:89], v4 offset:2048
    ds_read_b64_tr_b16 v[90:91], v4 offset:2560
    ds_read_b64_tr_b16 v[92:93], v5 offset:2048
    ds_read_b64_tr_b16 v[94:95], v5 offset:2560
    s_waitcnt vmcnt(2)
    v_mfma_f32_32x32x16_bf16 v[16:31], v[136:139], v[80:83], v[16:31]
    v_mfma_f32_32x32x16_bf16 v[32:47], v[140:143], v[80:83], v[32:47]
    v_mfma_f32_32x32x16_bf16 v[48:63], v[136:139], v[84:87], v[48:63]
    v_mfma_f32_32x32x16_bf16 v[64:79], v[140:143], v[84:87], v[64:79]
    s_waitcnt lgkmcnt(0)
    s_waitcnt vmcnt(0)
    v_mfma_f32_32x32x16_bf16 v[16:31], v[144:147], v[88:91], v[16:31]
    v_mfma_f32_32x32x16_bf16 v[32:47], v[148:151], v[88:91], v[32:47]
    v_mfma_f32_32x32x16_bf16 v[48:63], v[144:147], v[92:95], v[48:63]
    v_mfma_f32_32x32x16_bf16 v[64:79], v[148:151], v[92:95], v[64:79]
    s_setprio 3
    s_nop 8
    ds_write_b128 v8, v[32:35] offset:0
    ds_write_b128 v8, v[36:39] offset:1024
    ds_write_b128 v8, v[48:51] offset:2048
    ds_write_b128 v8, v[52:55] offset:3072
    ds_write_b128 v8, v[64:67] offset:4096
    ds_write_b128 v8, v[68:71] offset:5120
    v_mov_b32 v7, 3
    s_waitcnt lgkmcnt(0)
    ds_write_b32 v12, v7
    s_mov_b32 s14, s50
    s_and_b32 s11, s10, 1
    s_lshl_b32 s50, s11, 15
    v_lshrrev_b32 v4, 5, v0
    v_lshlrev_b32_e64 v4, 3, v4
    v_bfe_u32 v104, v0, 2, 2
    v_add_u32 v4, v4, v104
    v_lshlrev_b32 v4, 7, v4
    v_bfe_u32 v104, v0, 4, 1
    v_lshl_add_u32 v4, v104, 5, v4
    v_and_b32_e64 v104, 1, v0
    v_lshl_add_u32 v4, v104, 4, v4
    v_bfe_u32 v104, v0, 1, 1
    v_lshl_add_u32 v4, v104, 3, v4
    v_bfe_u32 v104, v0, 3, 1
    v_lshl_add_u32 v4, v104, 6, v4
    s_lshl_b32 s6, s11, 6
    v_xor_b32 v4, s6, v4
    v_add_u32 v4, s50, v4
    v_xor_b32 v5, 64, v4
    s_lshr_b32 s12, s10, 1
    s_lshl_b32 s6, s55, 1
    s_add_u32 s52, s6, s12
    s_lshl_b32 s52, s52, 15
    v_lshlrev_b32 v3, 4, v0
    s_lshl_b32 s6, s12, 15
    s_lshl_b32 s7, s11, 14
    s_add_u32 s6, s6, s7
    s_add_u32 s6, s6, 65536
    v_add_u32 v6, s6, v3
    v_and_b32 v106, 1, v0
    v_lshlrev_b32 v106, 3, v106
    s_lshl_b32 s6, s11, 4
    s_add_u32 s6, s6, 155792
    v_add_u32 v106, s6, v106
    v_add_u32 v107, 4, v106
    v_add_u32 v108, s14, v3
    s_xor_b32 s6, s10, 1
    s_mul_i32 s6, s6, 6144
    s_add_u32 s6, s6, 131072
    v_add_u32 v109, s6, v3
    v_and_b32 v110, 31, v0
    v_lshlrev_b32 v110, 10, v110
    v_lshrrev_b32 v104, 5, v0
    v_lshl_add_u32 v110, v104, 4, v110
    s_lshl_b32 s7, s54, 1
    s_add_u32 s7, s7, s11
    s_lshl_b32 s7, s7, 6
    s_add_u32 s15, s52, s7
    v_lshlrev_b32 v112, 16, v1
    v_sub_f32 v113, 1.0, v15
    v_mul_f32 v112, v112, v113
    s_mov_b32 s44, s34
    s_mov_b32 s45, s35
    s_mov_b32 s46, 0x200000
    s_mov_b32 s47, 0x20000
L_w_93:
    ds_read_b32 v7, v13
    s_waitcnt lgkmcnt(0)
    v_cmp_le_u32 vcc, 3, v7
    s_cmp_eq_u64 vcc, -1
    s_cbranch_scc1 L_wd_94
    s_sleep 0
    s_sub_u32 s70, s70, 1
    s_cmp_gt_i32 s70, 0
    s_cbranch_scc1 L_w_93
L_wd_94:
    ds_read_b128 v[80:83], v9 offset:0
    ds_read_b128 v[84:87], v9 offset:1024
    ds_read_b128 v[88:91], v10 offset:0
    ds_read_b128 v[92:95], v10 offset:1024
    ds_read_b128 v[96:99], v11 offset:0
    ds_read_b128 v[100:103], v11 offset:1024
    s_waitcnt lgkmcnt(0)
    ds_write_b128 v9, v[40:43] offset:0
    ds_write_b128 v9, v[44:47] offset:1024
    ds_write_b128 v10, v[56:59] offset:0
    ds_write_b128 v10, v[60:63] offset:1024
    ds_write_b128 v11, v[72:75] offset:0
    ds_write_b128 v11, v[76:79] offset:1024
    v_mov_b32 v7, 4
    s_waitcnt lgkmcnt(0)
    ds_write_b32 v12, v7
    v_pk_add_f32 v[16:17], v[16:17], v[80:81]
    v_pk_add_f32 v[88:89], v[88:89], v[96:97]
    v_pk_add_f32 v[18:19], v[18:19], v[82:83]
    v_pk_add_f32 v[90:91], v[90:91], v[98:99]
    v_pk_add_f32 v[20:21], v[20:21], v[84:85]
    v_pk_add_f32 v[92:93], v[92:93], v[100:101]
    v_pk_add_f32 v[22:23], v[22:23], v[86:87]
    v_pk_add_f32 v[94:95], v[94:95], v[102:103]
    v_pk_add_f32 v[16:17], v[16:17], v[88:89]
    v_pk_add_f32 v[18:19], v[18:19], v[90:91]
    v_pk_add_f32 v[20:21], v[20:21], v[92:93]
    v_pk_add_f32 v[22:23], v[22:23], v[94:95]
L_w_95:
    ds_read_b32 v7, v13
    s_waitcnt lgkmcnt(0)
    v_cmp_le_u32 vcc, 4, v7
    s_cmp_eq_u64 vcc, -1
    s_cbranch_scc1 L_wd_96
    s_sleep 0
    s_sub_u32 s70, s70, 1
    s_cmp_gt_i32 s70, 0
    s_cbranch_scc1 L_w_95
L_wd_96:
    ds_read_b128 v[80:83], v8 offset:0
    ds_read_b128 v[84:87], v8 offset:1024
    ds_read_b128 v[88:91], v8 offset:2048
    ds_read_b128 v[92:95], v8 offset:3072
    ds_read_b128 v[96:99], v8 offset:4096
    ds_read_b128 v[100:103], v8 offset:5120
    s_waitcnt lgkmcnt(0)
    s_nop 0
    v_pk_add_f32 v[24:25], v[24:25], v[80:81]
    v_pk_add_f32 v[88:89], v[88:89], v[96:97]
    v_pk_add_f32 v[26:27], v[26:27], v[82:83]
    v_pk_add_f32 v[90:91], v[90:91], v[98:99]
    v_pk_add_f32 v[28:29], v[28:29], v[84:85]
    v_pk_add_f32 v[92:93], v[92:93], v[100:101]
    v_pk_add_f32 v[30:31], v[30:31], v[86:87]
    v_pk_add_f32 v[94:95], v[94:95], v[102:103]
    v_pk_add_f32 v[24:25], v[24:25], v[88:89]
    v_pk_add_f32 v[26:27], v[26:27], v[90:91]
    v_pk_add_f32 v[28:29], v[28:29], v[92:93]
    v_pk_add_f32 v[30:31], v[30:31], v[94:95]
    v_fma_f32 v132, v16, v113, v112
    v_fma_f32 v133, v17, v113, v112
    v_fma_f32 v134, v18, v113, v112
    v_fma_f32 v135, v19, v113, v112
    v_fma_f32 v136, v20, v113, v112
    v_fma_f32 v137, v21, v113, v112
    v_fma_f32 v138, v22, v113, v112
    v_fma_f32 v139, v23, v113, v112
    v_fma_f32 v140, v24, v113, v112
    v_fma_f32 v141, v25, v113, v112
    v_fma_f32 v142, v26, v113, v112
    v_fma_f32 v143, v27, v113, v112
    v_fma_f32 v144, v28, v113, v112
    v_fma_f32 v145, v29, v113, v112
    v_fma_f32 v146, v30, v113, v112
    v_fma_f32 v147, v31, v113, v112
L_w_97:
    ds_read_b32 v8, v106
    s_waitcnt lgkmcnt(0)
    v_cmp_le_u32 vcc, 1, v8
    s_cmp_eq_u64 vcc, -1
    s_cbranch_scc1 L_wd_98
    s_sleep 1
    s_sub_u32 s70, s70, 1
    s_cmp_gt_i32 s70, 0
    s_cbranch_scc1 L_w_97
L_wd_98:
    ds_read_b128 v[72:75], v6 offset:0
    ds_read_b64_tr_b16 v[48:49], v4 offset:0
    ds_read_b64_tr_b16 v[50:51], v4 offset:512
    ds_read_b64_tr_b16 v[52:53], v5 offset:0
    ds_read_b64_tr_b16 v[54:55], v5 offset:512
    ds_read_b128 v[76:79], v6 offset:1024
    ds_read_b64_tr_b16 v[56:57], v4 offset:2048
    ds_read_b64_tr_b16 v[58:59], v4 offset:2560
    ds_read_b64_tr_b16 v[60:61], v5 offset:2048
    ds_read_b64_tr_b16 v[62:63], v5 offset:2560
    s_waitcnt lgkmcnt(5)
    s_nop 0
    v_mfma_f32_32x32x16_bf16 v[16:31], v[48:51], v[72:75], 0
    ds_read_b128 v[80:83], v6 offset:2048
    ds_read_b64_tr_b16 v[64:65], v4 offset:4096
    ds_read_b64_tr_b16 v[66:67], v4 offset:4608
    ds_read_b64_tr_b16 v[68:69], v5 offset:4096
    ds_read_b64_tr_b16 v[70:71], v5 offset:4608
    v_mfma_f32_32x32x16_bf16 v[32:47], v[52:55], v[72:75], 0
    s_waitcnt lgkmcnt(5)
    s_nop 0
    v_mfma_f32_32x32x16_bf16 v[16:31], v[56:59], v[76:79], v[16:31]
    ds_read_b128 v[72:75], v6 offset:3072
    ds_read_b64_tr_b16 v[48:49], v4 offset:6144
    ds_read_b64_tr_b16 v[50:51], v4 offset:6656
    ds_read_b64_tr_b16 v[52:53], v5 offset:6144
    ds_read_b64_tr_b16 v[54:55], v5 offset:6656
    v_mfma_f32_32x32x16_bf16 v[32:47], v[60:63], v[76:79], v[32:47]
    s_waitcnt lgkmcnt(5)
    s_nop 0
    v_mfma_f32_32x32x16_bf16 v[16:31], v[64:67], v[80:83], v[16:31]
    ds_read_b128 v[76:79], v6 offset:8192
    ds_read_b64_tr_b16 v[56:57], v4 offset:16384
    ds_read_b64_tr_b16 v[58:59], v4 offset:16896
    ds_read_b64_tr_b16 v[60:61], v5 offset:16384
    ds_read_b64_tr_b16 v[62:63], v5 offset:16896
    v_mfma_f32_32x32x16_bf16 v[32:47], v[68:71], v[80:83], v[32:47]
    s_waitcnt lgkmcnt(5)
    s_nop 0
    v_mfma_f32_32x32x16_bf16 v[16:31], v[48:51], v[72:75], v[16:31]
    ds_read_b128 v[80:83], v6 offset:9216
    ds_read_b64_tr_b16 v[64:65], v4 offset:18432
    ds_read_b64_tr_b16 v[66:67], v4 offset:18944
    ds_read_b64_tr_b16 v[68:69], v5 offset:18432
    ds_read_b64_tr_b16 v[70:71], v5 offset:18944
    v_mfma_f32_32x32x16_bf16 v[32:47], v[52:55], v[72:75], v[32:47]
    s_waitcnt lgkmcnt(5)
    s_nop 0
    v_mfma_f32_32x32x16_bf16 v[16:31], v[56:59], v[76:79], v[16:31]
    ds_read_b128 v[72:75], v6 offset:10240
    ds_read_b64_tr_b16 v[48:49], v4 offset:20480
    ds_read_b64_tr_b16 v[50:51], v4 offset:20992
    ds_read_b64_tr_b16 v[52:53], v5 offset:20480
    ds_read_b64_tr_b16 v[54:55], v5 offset:20992
    v_mfma_f32_32x32x16_bf16 v[32:47], v[60:63], v[76:79], v[32:47]
    s_waitcnt lgkmcnt(5)
    s_nop 0
    v_mfma_f32_32x32x16_bf16 v[16:31], v[64:67], v[80:83], v[16:31]
    ds_read_b128 v[76:79], v6 offset:11264
    ds_read_b64_tr_b16 v[56:57], v4 offset:22528
    ds_read_b64_tr_b16 v[58:59], v4 offset:23040
    ds_read_b64_tr_b16 v[60:61], v5 offset:22528
    ds_read_b64_tr_b16 v[62:63], v5 offset:23040
    v_mfma_f32_32x32x16_bf16 v[32:47], v[68:71], v[80:83], v[32:47]
    s_waitcnt lgkmcnt(5)
    s_nop 0
    v_mfma_f32_32x32x16_bf16 v[16:31], v[48:51], v[72:75], v[16:31]
    v_mfma_f32_32x32x16_bf16 v[32:47], v[52:55], v[72:75], v[32:47]
    s_waitcnt lgkmcnt(0)
    s_nop 0
    v_mfma_f32_32x32x16_bf16 v[16:31], v[56:59], v[76:79], v[16:31]
    v_mfma_f32_32x32x16_bf16 v[32:47], v[60:63], v[76:79], v[32:47]
L_w_99:
    ds_read_b32 v8, v107
    s_waitcnt lgkmcnt(0)
    v_cmp_le_u32 vcc, 1, v8
    s_cmp_eq_u64 vcc, -1
    s_cbranch_scc1 L_wd_100
    s_sleep 1
    s_sub_u32 s70, s70, 1
    s_cmp_gt_i32 s70, 0
    s_cbranch_scc1 L_w_99
L_wd_100:
    ds_read_b128 v[80:83], v6 offset:4096
    ds_read_b64_tr_b16 v[64:65], v4 offset:8192
    ds_read_b64_tr_b16 v[66:67], v4 offset:8704
    ds_read_b64_tr_b16 v[68:69], v5 offset:8192
    ds_read_b64_tr_b16 v[70:71], v5 offset:8704
    ds_read_b128 v[72:75], v6 offset:5120
    ds_read_b64_tr_b16 v[48:49], v4 offset:10240
    ds_read_b64_tr_b16 v[50:51], v4 offset:10752
    ds_read_b64_tr_b16 v[52:53], v5 offset:10240
    ds_read_b64_tr_b16 v[54:55], v5 offset:10752
    s_waitcnt lgkmcnt(5)
    s_nop 0
    v_mfma_f32_32x32x16_bf16 v[16:31], v[64:67], v[80:83], v[16:31]
    ds_read_b128 v[76:79], v6 offset:6144
    ds_read_b64_tr_b16 v[56:57], v4 offset:12288
    ds_read_b64_tr_b16 v[58:59], v4 offset:12800
    ds_read_b64_tr_b16 v[60:61], v5 offset:12288
    ds_read_b64_tr_b16 v[62:63], v5 offset:12800
    v_mfma_f32_32x32x16_bf16 v[32:47], v[68:71], v[80:83], v[32:47]
    s_waitcnt lgkmcnt(5)
    s_nop 0
    v_mfma_f32_32x32x16_bf16 v[16:31], v[48:51], v[72:75], v[16:31]
    ds_read_b128 v[80:83], v6 offset:7168
    ds_read_b64_tr_b16 v[64:65], v4 offset:14336
    ds_read_b64_tr_b16 v[66:67], v4 offset:14848
    ds_read_b64_tr_b16 v[68:69], v5 offset:14336
    ds_read_b64_tr_b16 v[70:71], v5 offset:14848
    v_mfma_f32_32x32x16_bf16 v[32:47], v[52:55], v[72:75], v[32:47]
    s_waitcnt lgkmcnt(5)
    s_nop 0
    v_mfma_f32_32x32x16_bf16 v[16:31], v[56:59], v[76:79], v[16:31]
    ds_read_b128 v[72:75], v6 offset:12288
    ds_read_b64_tr_b16 v[48:49], v4 offset:24576
    ds_read_b64_tr_b16 v[50:51], v4 offset:25088
    ds_read_b64_tr_b16 v[52:53], v5 offset:24576
    ds_read_b64_tr_b16 v[54:55], v5 offset:25088
    v_mfma_f32_32x32x16_bf16 v[32:47], v[60:63], v[76:79], v[32:47]
    s_waitcnt lgkmcnt(5)
    s_nop 0
    v_mfma_f32_32x32x16_bf16 v[16:31], v[64:67], v[80:83], v[16:31]
    ds_read_b128 v[76:79], v6 offset:13312
    ds_read_b64_tr_b16 v[56:57], v4 offset:26624
    ds_read_b64_tr_b16 v[58:59], v4 offset:27136
    ds_read_b64_tr_b16 v[60:61], v5 offset:26624
    ds_read_b64_tr_b16 v[62:63], v5 offset:27136
    v_mfma_f32_32x32x16_bf16 v[32:47], v[68:71], v[80:83], v[32:47]
    s_waitcnt lgkmcnt(5)
    s_nop 0
    v_mfma_f32_32x32x16_bf16 v[16:31], v[48:51], v[72:75], v[16:31]
    ds_read_b128 v[80:83], v6 offset:14336
    ds_read_b64_tr_b16 v[64:65], v4 offset:28672
    ds_read_b64_tr_b16 v[66:67], v4 offset:29184
    ds_read_b64_tr_b16 v[68:69], v5 offset:28672
    ds_read_b64_tr_b16 v[70:71], v5 offset:29184
    v_mfma_f32_32x32x16_bf16 v[32:47], v[52:55], v[72:75], v[32:47]
    s_waitcnt lgkmcnt(5)
    s_nop 0
    v_mfma_f32_32x32x16_bf16 v[16:31], v[56:59], v[76:79], v[16:31]
    ds_read_b128 v[72:75], v6 offset:15360
    ds_read_b64_tr_b16 v[48:49], v4 offset:30720
    ds_read_b64_tr_b16 v[50:51], v4 offset:31232
    ds_read_b64_tr_b16 v[52:53], v5 offset:30720
    ds_read_b64_tr_b16 v[54:55], v5 offset:31232
    v_mfma_f32_32x32x16_bf16 v[32:47], v[60:63], v[76:79], v[32:47]
    s_waitcnt lgkmcnt(5)
    s_nop 0
    v_mfma_f32_32x32x16_bf16 v[16:31], v[64:67], v[80:83], v[16:31]
    v_mfma_f32_32x32x16_bf16 v[32:47], v[68:71], v[80:83], v[32:47]
    s_waitcnt lgkmcnt(0)
    s_nop 0
    v_mfma_f32_32x32x16_bf16 v[16:31], v[48:51], v[72:75], v[16:31]
    v_mfma_f32_32x32x16_bf16 v[32:47], v[52:55], v[72:75], v[32:47]
    s_nop 11
    ds_write_b128 v108, v[32:35] offset:0
    ds_write_b128 v108, v[36:39] offset:1024
    ds_write_b128 v108, v[40:43] offset:2048
    ds_write_b128 v108, v[44:47] offset:3072
    v_mov_b32_e64 v10, 5
    s_waitcnt lgkmcnt(0)
    ds_write_b32 v12, v10
    v_fma_f32 v16, v16, v15, v132
    v_fma_f32 v17, v17, v15, v133
    v_fma_f32 v18, v18, v15, v134
    v_fma_f32 v19, v19, v15, v135
    v_fma_f32 v20, v20, v15, v136
    v_fma_f32 v21, v21, v15, v137
    v_fma_f32 v22, v22, v15, v138
    v_fma_f32 v23, v23, v15, v139
    v_fma_f32 v24, v24, v15, v140
    v_fma_f32 v25, v25, v15, v141
    v_fma_f32 v26, v26, v15, v142
    v_fma_f32 v27, v27, v15, v143
    v_fma_f32 v28, v28, v15, v144
    v_fma_f32 v29, v29, v15, v145
    v_fma_f32 v30, v30, v15, v146
    v_fma_f32 v31, v31, v15, v147
L_w_101:
    ds_read_b32 v10, v13
    s_waitcnt lgkmcnt(0)
    v_cmp_le_u32 vcc, 5, v10
    s_cmp_eq_u64 vcc, -1
    s_cbranch_scc1 L_wd_102
    s_sleep 0
    s_sub_u32 s70, s70, 1
    s_cmp_gt_i32 s70, 0
    s_cbranch_scc1 L_w_101
L_wd_102:
    ds_read_b128 v[64:67], v109 offset:0
    ds_read_b128 v[68:71], v109 offset:1024
    ds_read_b128 v[72:75], v109 offset:2048
    ds_read_b128 v[76:79], v109 offset:3072
    s_waitcnt lgkmcnt(0)
    s_nop 0
    v_fma_f32 v16, v64, v15, v16
    v_fma_f32 v17, v65, v15, v17
    v_fma_f32 v18, v66, v15, v18
    v_fma_f32 v19, v67, v15, v19
    v_fma_f32 v20, v68, v15, v20
    v_fma_f32 v21, v69, v15, v21
    v_fma_f32 v22, v70, v15, v22
    v_fma_f32 v23, v71, v15, v23
    v_fma_f32 v24, v72, v15, v24
    v_fma_f32 v25, v73, v15, v25
    v_fma_f32 v26, v74, v15, v26
    v_fma_f32 v27, v75, v15, v27
    v_fma_f32 v28, v76, v15, v28
    v_fma_f32 v29, v77, v15, v29
    v_fma_f32 v30, v78, v15, v30
    v_fma_f32 v31, v79, v15, v31
    v_cvt_pk_bf16_f32 v64, v16, v17
    v_cvt_pk_bf16_f32 v65, v18, v19
    v_cvt_pk_bf16_f32 v66, v20, v21
    v_cvt_pk_bf16_f32 v67, v22, v23
    v_cvt_pk_bf16_f32 v68, v24, v25
    v_cvt_pk_bf16_f32 v69, v26, v27
    v_cvt_pk_bf16_f32 v70, v28, v29
    v_cvt_pk_bf16_f32 v71, v30, v31
    buffer_store_dwordx4 v[64:67], v110, s[44:47], s15 offen
    buffer_store_dwordx4 v[68:71], v110, s[44:47], s15 offen offset:32
    s_or_b32 s6, s2, s10
    s_cmp_lg_u32 s6, 0
    s_cbranch_scc1 L_nogen_103
    s_mov_b32 s6, 131072
    v_mov_b32 v7, s71
    v_lshlrev_b32 v8, 14, v0
    s_mov_b64 exec, 1
    buffer_store_dword v7, v8, s[56:59], s6 offen sc1
    s_mov_b64 exec, -1
L_nogen_103:
L_end:
    s_endpgm
.section .rodata,"a"
.p2align 6
.amdhsa_kernel gated_mix__softmax_full_mha__mixer_token_mlp__prompt_kernel
  .amdhsa_next_free_vgpr 168
  .amdhsa_next_free_sgpr 96
  .amdhsa_accum_offset 168
  .amdhsa_group_segment_fixed_size 0
  .amdhsa_kernarg_size 96
  .amdhsa_user_sgpr_count 2
  .amdhsa_user_sgpr_kernarg_segment_ptr 1
  .amdhsa_system_sgpr_workgroup_id_x 1
.end_amdhsa_kernel
```
